```python
import torch

def _softmax(x, axis=-1):
    return torch.softmax(x, dim=axis)
def _gelu(x):
    return torch.nn.functional.gelu(x, approximate="tanh")
def _silu(x):
    return torch.nn.functional.silu(x)
def _sigmoid(x):
    return torch.sigmoid(x)
def _layernorm(x, axis=-1, eps=1e-5):
    m = x.mean(dim=axis, keepdim=True)
    v = x.var(dim=axis, keepdim=True, unbiased=False)
    return (x - m) / torch.sqrt(v + eps)
def _scatter_add(tgt, idx, src, axis=0):
    return tgt.clone().index_add_(axis, idx, src)
def _segment_sum(src, seg, n):
    out = torch.zeros((n,) + src.shape[1:], dtype=src.dtype)
    return out.index_add_(0, seg, src)
def _pad(x, pw):
    flat = tuple(v for pair in reversed(pw) for v in pair)
    return torch.nn.functional.pad(x, flat)

kernel_name = 'parallel_sum__sliding_local_dilated__mixer_token_mlp__prompt'

def setup_inputs():

    _w = (lambda a: (lambda t: t.to(torch.bfloat16) if t.is_floating_point() else t)(torch.as_tensor(a)))
    def _A_setup():
        B, S, D = 1, 2048, 640
        return {
            "x": _w((lambda *s: torch.randn(*s, dtype=torch.bfloat16) * 0.05)(B, S, D)),
            "wqkv": _w((lambda *s: torch.randn(*s, dtype=torch.bfloat16) * 0.05)(D, 3 * D)),
            "wo": _w((lambda *s: torch.randn(*s, dtype=torch.bfloat16) * 0.05)(D, D)),
        }
    _A_in = _A_setup()

    def _B_setup():
        B, S, D, F = 1, 2048, 640, 1728
        return {
            "x": _w((lambda *s: torch.randn(*s, dtype=torch.bfloat16) * 0.05)(B, S, D)),
            "w1": _w((lambda *s: torch.randn(*s, dtype=torch.bfloat16) * 0.8)(S, F) * (S ** -0.5)),
            "b1": _w((lambda *s: torch.randn(*s, dtype=torch.bfloat16) * 0.8)(F) * 0.02),
            "w2": _w((lambda *s: torch.randn(*s, dtype=torch.bfloat16) * 0.8)(F, S) * (F ** -0.5)),
            "b2": _w((lambda *s: torch.randn(*s, dtype=torch.bfloat16) * 0.8)(S) * 0.02),
        }
    _B_in = _B_setup()

    return {
        "A_x": _A_in["x"],
        "A_wqkv": _A_in["wqkv"],
        "A_wo": _A_in["wo"],
        "B_x": _B_in["x"],
        "B_w1": _B_in["w1"],
        "B_b1": _B_in["b1"],
        "B_w2": _B_in["w2"],
        "B_b2": _B_in["b2"],
    }

def reference(A_x, A_wqkv, A_wo, B_x, B_w1, B_b1, B_w2, B_b2):
    def _A_ref(x, wqkv, wo):
        B, S, D = x.shape
        H = 32; Dh = D // H
        W, dil = 8, 2
        qkv = (lambda x, *d: x.permute(*d))((x @ wqkv).reshape(B, S, 3, H, Dh), 2, 0, 3, 1, 4)
        q, k, v = qkv[0], qkv[1], qkv[2]
        scale = Dh ** -0.5
        pos = torch.arange(S)
        off = torch.arange(W) * dil
        idx = pos[:, None] - off[None, :]
        mask = idx >= 0
        idx_c = torch.where(mask, idx, 0).reshape(-1)
        kg = k[:, :, idx_c, :].reshape(B, H, S, W, Dh)
        vg = v[:, :, idx_c, :].reshape(B, H, S, W, Dh)
        logits = torch.einsum("bhsd,bhswd->bhsw", q, kg) * scale
        logits = torch.where(mask[None, None, :, :], logits, -1e9)
        attn = _softmax(logits, axis=-1)
        o = torch.einsum("bhsw,bhswd->bhsd", attn, vg)
        return (lambda x, *d: x.permute(*d))(o, 0, 2, 1, 3).reshape(B, S, D) @ wo

    def _B_ref(x, w1, b1, w2, b2):
        B, S, D = x.shape
        h = _layernorm(x, axis=-1)
        u = torch.einsum("bsd,sf->bdf", h, w1) + b1
        u = _gelu(u)
        y = torch.einsum("bdf,fs->bds", u, w2) + b2
        return (lambda x, *d: x.permute(*d))(y, 0, 2, 1)

    x = A_x
    xn = _layernorm(x, axis=-1)
    return x + _A_ref(xn, A_wqkv, A_wo) + _B_ref(xn, B_w1, B_b1, B_w2, B_b2)
```

```asm
; @launch grid=(256,1,1) block=(512,1,1) lds=163840
.amdgcn_target "amdgcn-amd-amdhsa--gfx950"
.text
.globl parallel_sum__sliding_local_dilated__mixer_token_mlp__prompt_kernel
.p2align 8
.type parallel_sum__sliding_local_dilated__mixer_token_mlp__prompt_kernel,@function
parallel_sum__sliding_local_dilated__mixer_token_mlp__prompt_kernel:
  s_cmp_ge_u32 s2, 256
  s_cbranch_scc1 K_END
  s_load_dwordx16 s[72:87], s[0:1], 0
  s_load_dwordx4 s[88:91], s[0:1], 64
  s_load_dwordx2 s[92:93], s[0:1], 80
  v_lshrrev_b32 v1, 6, v0
  s_nop 0
  v_readfirstlane_b32 s24, v1
  v_and_b32 v1, 63, v0
  v_mov_b32 v2, 163776
  v_mov_b32 v4, 0
  v_mov_b32 v5, 0
  v_mov_b32 v6, 0
  v_mov_b32 v7, 0
  ds_write_b128 v2, v[4:7]
  ds_write_b128 v2, v[4:7] offset:16
  ds_write_b128 v2, v[4:7] offset:32
  s_waitcnt lgkmcnt(0)
  s_mov_b32 s16, s92
  s_and_b32 s17, s93, 0xffff
  s_mov_b32 s18, 13631488
  s_mov_b32 s19, 0x20000
  s_load_dword s95, s[92:93], 49152
  s_barrier
  s_cmp_lt_u32 s24, 2
  s_cbranch_scc1 P0_LN
  s_cmp_eq_u32 s24, 2
  s_cbranch_scc1 P0_WARM
  s_cmp_eq_u32 s24, 3
  s_cbranch_scc1 P0_WO
  s_cmp_ge_u32 s2, 8
  s_cbranch_scc1 P0_NOCODE
  s_cmp_lg_u32 s24, 7
  s_cbranch_scc1 P0_NOCODE
  s_getpc_b64 s[46:47]
P0_PC:
  s_add_u32 s46, s46, P0_LN-P0_PC
  s_addc_u32 s47, s47, 0
  s_mov_b32 s48, K_END-P0_LN
  v_lshlrev_b32 v42, 7, v1
  v_add_u32 v42, 0, v42
  v_min_u32 v42, s48, v42
  v_mov_b32 v43, s47
  v_add_co_u32 v42, vcc, s46, v42
  s_nop 1
  v_addc_co_u32 v43, vcc, 0, v43, vcc
  global_load_dword v253, v[42:43], off
  v_lshlrev_b32 v42, 7, v1
  v_add_u32 v42, 8192, v42
  v_min_u32 v42, s48, v42
  v_mov_b32 v43, s47
  v_add_co_u32 v42, vcc, s46, v42
  s_nop 1
  v_addc_co_u32 v43, vcc, 0, v43, vcc
  global_load_dword v253, v[42:43], off
  v_lshlrev_b32 v42, 7, v1
  v_add_u32 v42, 16384, v42
  v_min_u32 v42, s48, v42
  v_mov_b32 v43, s47
  v_add_co_u32 v42, vcc, s46, v42
  s_nop 1
  v_addc_co_u32 v43, vcc, 0, v43, vcc
  global_load_dword v253, v[42:43], off
  v_lshlrev_b32 v42, 7, v1
  v_add_u32 v42, 24576, v42
  v_min_u32 v42, s48, v42
  v_mov_b32 v43, s47
  v_add_co_u32 v42, vcc, s46, v42
  s_nop 1
  v_addc_co_u32 v43, vcc, 0, v43, vcc
  global_load_dword v253, v[42:43], off
P0_NOCODE:
  s_waitcnt lgkmcnt(0)
  s_mul_i32 s94, s95, 0x9e3779b1
  s_add_u32 s94, s94, 0x7f4a7c15
  v_mov_b32 v6, 163776
  s_mov_b32 s37, 0
P0_TWAIT:
  ds_read_b32 v7, v6
  s_waitcnt lgkmcnt(0)
  v_readfirstlane_b32 s38, v7
  s_add_u32 s37, s37, 1
  s_cmp_ge_u32 s38, 2
  s_cbranch_scc1 P0_TWAIT_OK
  s_cmp_lt_u32 s37, 0x400000
  s_cbranch_scc0 P0_TWAIT_OK
  s_sleep 1
  s_branch P0_TWAIT
P0_TWAIT_OK:
  s_branch P0_DONE
P0_LN:
  v_and_b32 v2, 15, v1
  v_lshrrev_b32 v3, 4, v1
  s_lshl_b32 s25, s2, 3
  s_lshl_b32 s26, s24, 2
  s_add_u32 s25, s25, s26
  v_add_u32 v3, s25, v3
  v_mul_u32_u24 v4, 1280, v3
  v_lshl_add_u32 v4, v2, 4, v4
  s_mov_b32 s20, s72
  s_and_b32 s21, s73, 0xffff
  s_mov_b32 s22, 2621440
  s_mov_b32 s23, 0x20000
  buffer_load_dwordx4 v[8:11], v4, s[20:23], 0 offen offset:0
  buffer_load_dwordx4 v[12:15], v4, s[20:23], 0 offen offset:256
  buffer_load_dwordx4 v[16:19], v4, s[20:23], 0 offen offset:512
  buffer_load_dwordx4 v[20:23], v4, s[20:23], 0 offen offset:768
  buffer_load_dwordx4 v[24:27], v4, s[20:23], 0 offen offset:1024
  v_lshrrev_b32 v5, 4, v3
  v_mul_u32_u24 v5, 20480, v5
  v_and_b32 v6, 15, v3
  v_lshl_add_u32 v5, v6, 4, v5
  v_lshrrev_b32 v6, 2, v2
  v_lshl_add_u32 v5, v6, 10, v5
  v_and_b32 v6, 3, v2
  v_lshl_add_u32 v5, v6, 8, v5
  v_add_u32 v5, 65536, v5
  v_mul_u32_u24 v7, 160, v3
  v_add_u32 v7, 2686976, v7
  s_mov_b32 s27, 327680
  v_add_u32 v6, 0, v2
  v_mul_u32_u24 v68, 6554, v6
  v_lshrrev_b32 v68, 16, v68
  v_mul_u32_u24 v69, 10, v68
  v_sub_u32 v6, v6, v69
  v_mul_lo_u32 v68, v68, s27
  v_lshl_add_u32 v68, v6, 4, v68
  v_add_u32 v112, v68, v7
  v_add_u32 v6, 16, v2
  v_mul_u32_u24 v68, 6554, v6
  v_lshrrev_b32 v68, 16, v68
  v_mul_u32_u24 v69, 10, v68
  v_sub_u32 v6, v6, v69
  v_mul_lo_u32 v68, v68, s27
  v_lshl_add_u32 v68, v6, 4, v68
  v_add_u32 v113, v68, v7
  v_add_u32 v6, 32, v2
  v_mul_u32_u24 v68, 6554, v6
  v_lshrrev_b32 v68, 16, v68
  v_mul_u32_u24 v69, 10, v68
  v_sub_u32 v6, v6, v69
  v_mul_lo_u32 v68, v68, s27
  v_lshl_add_u32 v68, v6, 4, v68
  v_add_u32 v114, v68, v7
  v_add_u32 v6, 48, v2
  v_mul_u32_u24 v68, 6554, v6
  v_lshrrev_b32 v68, 16, v68
  v_mul_u32_u24 v69, 10, v68
  v_sub_u32 v6, v6, v69
  v_mul_lo_u32 v68, v68, s27
  v_lshl_add_u32 v68, v6, 4, v68
  v_add_u32 v115, v68, v7
  v_add_u32 v6, 64, v2
  v_mul_u32_u24 v68, 6554, v6
  v_lshrrev_b32 v68, 16, v68
  v_mul_u32_u24 v69, 10, v68
  v_sub_u32 v6, v6, v69
  v_mul_lo_u32 v68, v68, s27
  v_lshl_add_u32 v68, v6, 4, v68
  v_add_u32 v116, v68, v7
  s_mov_b32 s31, 4096
  s_mov_b32 s32, 8192
  s_mov_b32 s33, 12288
  s_mov_b32 s34, 16384
  v_mov_b32 v70, 0x3acccccd
  v_mov_b32 v71, 0x3727c5ac
  s_waitcnt vmcnt(4)
  v_lshlrev_b32 v28, 16, v8
  v_and_b32 v29, 0xffff0000, v8
  v_lshlrev_b32 v30, 16, v9
  v_and_b32 v31, 0xffff0000, v9
  v_lshlrev_b32 v32, 16, v10
  v_and_b32 v33, 0xffff0000, v10
  v_lshlrev_b32 v34, 16, v11
  v_and_b32 v35, 0xffff0000, v11
  s_waitcnt vmcnt(3)
  v_lshlrev_b32 v36, 16, v12
  v_and_b32 v37, 0xffff0000, v12
  v_lshlrev_b32 v38, 16, v13
  v_and_b32 v39, 0xffff0000, v13
  v_lshlrev_b32 v40, 16, v14
  v_and_b32 v41, 0xffff0000, v14
  v_lshlrev_b32 v42, 16, v15
  v_and_b32 v43, 0xffff0000, v15
  s_waitcnt vmcnt(2)
  v_lshlrev_b32 v44, 16, v16
  v_and_b32 v45, 0xffff0000, v16
  v_lshlrev_b32 v46, 16, v17
  v_and_b32 v47, 0xffff0000, v17
  v_lshlrev_b32 v48, 16, v18
  v_and_b32 v49, 0xffff0000, v18
  v_lshlrev_b32 v50, 16, v19
  v_and_b32 v51, 0xffff0000, v19
  s_waitcnt vmcnt(1)
  v_lshlrev_b32 v52, 16, v20
  v_and_b32 v53, 0xffff0000, v20
  v_lshlrev_b32 v54, 16, v21
  v_and_b32 v55, 0xffff0000, v21
  v_lshlrev_b32 v56, 16, v22
  v_and_b32 v57, 0xffff0000, v22
  v_lshlrev_b32 v58, 16, v23
  v_and_b32 v59, 0xffff0000, v23
  s_waitcnt vmcnt(0)
  v_lshlrev_b32 v60, 16, v24
  v_and_b32 v61, 0xffff0000, v24
  v_lshlrev_b32 v62, 16, v25
  v_and_b32 v63, 0xffff0000, v25
  v_lshlrev_b32 v64, 16, v26
  v_and_b32 v65, 0xffff0000, v26
  v_lshlrev_b32 v66, 16, v27
  v_and_b32 v67, 0xffff0000, v27
  v_pk_add_f32 v[92:93], v[28:29], v[36:37]
  v_pk_add_f32 v[94:95], v[30:31], v[38:39]
  v_pk_add_f32 v[96:97], v[32:33], v[40:41]
  v_pk_add_f32 v[98:99], v[34:35], v[42:43]
  v_pk_add_f32 v[92:93], v[92:93], v[44:45]
  v_pk_add_f32 v[94:95], v[94:95], v[46:47]
  v_pk_add_f32 v[96:97], v[96:97], v[48:49]
  v_pk_add_f32 v[98:99], v[98:99], v[50:51]
  v_pk_add_f32 v[92:93], v[92:93], v[52:53]
  v_pk_add_f32 v[94:95], v[94:95], v[54:55]
  v_pk_add_f32 v[96:97], v[96:97], v[56:57]
  v_pk_add_f32 v[98:99], v[98:99], v[58:59]
  v_pk_add_f32 v[92:93], v[92:93], v[60:61]
  v_pk_add_f32 v[94:95], v[94:95], v[62:63]
  v_pk_add_f32 v[96:97], v[96:97], v[64:65]
  v_pk_add_f32 v[98:99], v[98:99], v[66:67]
  v_pk_add_f32 v[92:93], v[92:93], v[94:95]
  v_pk_add_f32 v[96:97], v[96:97], v[98:99]
  v_pk_add_f32 v[92:93], v[92:93], v[96:97]
  v_add_f32 v92, v92, v93
  s_nop 1
  v_add_f32_dpp v92, v92, v92 row_ror:8 row_mask:0xf bank_mask:0xf
  s_nop 1
  v_add_f32_dpp v92, v92, v92 row_ror:4 row_mask:0xf bank_mask:0xf
  s_nop 1
  v_add_f32_dpp v92, v92, v92 row_ror:2 row_mask:0xf bank_mask:0xf
  s_nop 1
  v_add_f32_dpp v92, v92, v92 row_ror:1 row_mask:0xf bank_mask:0xf
  v_mul_f32 v92, v70, v92
  v_sub_f32 v100, 0, v92
  v_pk_add_f32 v[28:29], v[28:29], v[100:101] op_sel_hi:[1,0]
  v_pk_add_f32 v[30:31], v[30:31], v[100:101] op_sel_hi:[1,0]
  v_pk_add_f32 v[32:33], v[32:33], v[100:101] op_sel_hi:[1,0]
  v_pk_add_f32 v[34:35], v[34:35], v[100:101] op_sel_hi:[1,0]
  v_pk_add_f32 v[36:37], v[36:37], v[100:101] op_sel_hi:[1,0]
  v_pk_add_f32 v[38:39], v[38:39], v[100:101] op_sel_hi:[1,0]
  v_pk_add_f32 v[40:41], v[40:41], v[100:101] op_sel_hi:[1,0]
  v_pk_add_f32 v[42:43], v[42:43], v[100:101] op_sel_hi:[1,0]
  v_pk_add_f32 v[44:45], v[44:45], v[100:101] op_sel_hi:[1,0]
  v_pk_add_f32 v[46:47], v[46:47], v[100:101] op_sel_hi:[1,0]
  v_pk_add_f32 v[48:49], v[48:49], v[100:101] op_sel_hi:[1,0]
  v_pk_add_f32 v[50:51], v[50:51], v[100:101] op_sel_hi:[1,0]
  v_pk_add_f32 v[52:53], v[52:53], v[100:101] op_sel_hi:[1,0]
  v_pk_add_f32 v[54:55], v[54:55], v[100:101] op_sel_hi:[1,0]
  v_pk_add_f32 v[56:57], v[56:57], v[100:101] op_sel_hi:[1,0]
  v_pk_add_f32 v[58:59], v[58:59], v[100:101] op_sel_hi:[1,0]
  v_pk_add_f32 v[60:61], v[60:61], v[100:101] op_sel_hi:[1,0]
  v_pk_add_f32 v[62:63], v[62:63], v[100:101] op_sel_hi:[1,0]
  v_pk_add_f32 v[64:65], v[64:65], v[100:101] op_sel_hi:[1,0]
  v_pk_add_f32 v[66:67], v[66:67], v[100:101] op_sel_hi:[1,0]
  v_pk_mul_f32 v[92:93], v[28:29], v[28:29]
  v_pk_mul_f32 v[94:95], v[30:31], v[30:31]
  v_pk_mul_f32 v[96:97], v[32:33], v[32:33]
  v_pk_mul_f32 v[98:99], v[34:35], v[34:35]
  v_pk_fma_f32 v[92:93], v[36:37], v[36:37], v[92:93]
  v_pk_fma_f32 v[94:95], v[38:39], v[38:39], v[94:95]
  v_pk_fma_f32 v[96:97], v[40:41], v[40:41], v[96:97]
  v_pk_fma_f32 v[98:99], v[42:43], v[42:43], v[98:99]
  v_pk_fma_f32 v[92:93], v[44:45], v[44:45], v[92:93]
  v_pk_fma_f32 v[94:95], v[46:47], v[46:47], v[94:95]
  v_pk_fma_f32 v[96:97], v[48:49], v[48:49], v[96:97]
  v_pk_fma_f32 v[98:99], v[50:51], v[50:51], v[98:99]
  v_pk_fma_f32 v[92:93], v[52:53], v[52:53], v[92:93]
  v_pk_fma_f32 v[94:95], v[54:55], v[54:55], v[94:95]
  v_pk_fma_f32 v[96:97], v[56:57], v[56:57], v[96:97]
  v_pk_fma_f32 v[98:99], v[58:59], v[58:59], v[98:99]
  v_pk_fma_f32 v[92:93], v[60:61], v[60:61], v[92:93]
  v_pk_fma_f32 v[94:95], v[62:63], v[62:63], v[94:95]
  v_pk_fma_f32 v[96:97], v[64:65], v[64:65], v[96:97]
  v_pk_fma_f32 v[98:99], v[66:67], v[66:67], v[98:99]
  v_pk_add_f32 v[92:93], v[92:93], v[94:95]
  v_pk_add_f32 v[96:97], v[96:97], v[98:99]
  v_pk_add_f32 v[92:93], v[92:93], v[96:97]
  v_add_f32 v92, v92, v93
  s_nop 1
  v_add_f32_dpp v92, v92, v92 row_ror:8 row_mask:0xf bank_mask:0xf
  s_nop 1
  v_add_f32_dpp v92, v92, v92 row_ror:4 row_mask:0xf bank_mask:0xf
  s_nop 1
  v_add_f32_dpp v92, v92, v92 row_ror:2 row_mask:0xf bank_mask:0xf
  s_nop 1
  v_add_f32_dpp v92, v92, v92 row_ror:1 row_mask:0xf bank_mask:0xf
  v_fma_f32 v92, v92, v70, v71
  v_rsq_f32 v102, v92
  s_nop 0
  v_pk_mul_f32 v[28:29], v[28:29], v[102:103] op_sel_hi:[1,0]
  v_pk_mul_f32 v[30:31], v[30:31], v[102:103] op_sel_hi:[1,0]
  v_pk_mul_f32 v[32:33], v[32:33], v[102:103] op_sel_hi:[1,0]
  v_pk_mul_f32 v[34:35], v[34:35], v[102:103] op_sel_hi:[1,0]
  v_pk_mul_f32 v[36:37], v[36:37], v[102:103] op_sel_hi:[1,0]
  v_pk_mul_f32 v[38:39], v[38:39], v[102:103] op_sel_hi:[1,0]
  v_pk_mul_f32 v[40:41], v[40:41], v[102:103] op_sel_hi:[1,0]
  v_pk_mul_f32 v[42:43], v[42:43], v[102:103] op_sel_hi:[1,0]
  v_pk_mul_f32 v[44:45], v[44:45], v[102:103] op_sel_hi:[1,0]
  v_pk_mul_f32 v[46:47], v[46:47], v[102:103] op_sel_hi:[1,0]
  v_pk_mul_f32 v[48:49], v[48:49], v[102:103] op_sel_hi:[1,0]
  v_pk_mul_f32 v[50:51], v[50:51], v[102:103] op_sel_hi:[1,0]
  v_pk_mul_f32 v[52:53], v[52:53], v[102:103] op_sel_hi:[1,0]
  v_pk_mul_f32 v[54:55], v[54:55], v[102:103] op_sel_hi:[1,0]
  v_pk_mul_f32 v[56:57], v[56:57], v[102:103] op_sel_hi:[1,0]
  v_pk_mul_f32 v[58:59], v[58:59], v[102:103] op_sel_hi:[1,0]
  v_pk_mul_f32 v[60:61], v[60:61], v[102:103] op_sel_hi:[1,0]
  v_pk_mul_f32 v[62:63], v[62:63], v[102:103] op_sel_hi:[1,0]
  v_pk_mul_f32 v[64:65], v[64:65], v[102:103] op_sel_hi:[1,0]
  v_pk_mul_f32 v[66:67], v[66:67], v[102:103] op_sel_hi:[1,0]
  v_cvt_pk_bf16_f32 v8, v28, v29
  v_cvt_pk_bf16_f32 v9, v30, v31
  v_cvt_pk_bf16_f32 v10, v32, v33
  v_cvt_pk_bf16_f32 v11, v34, v35
  v_cvt_pk_bf16_f32 v12, v36, v37
  v_cvt_pk_bf16_f32 v13, v38, v39
  v_cvt_pk_bf16_f32 v14, v40, v41
  v_cvt_pk_bf16_f32 v15, v42, v43
  v_cvt_pk_bf16_f32 v16, v44, v45
  v_cvt_pk_bf16_f32 v17, v46, v47
  v_cvt_pk_bf16_f32 v18, v48, v49
  v_cvt_pk_bf16_f32 v19, v50, v51
  v_cvt_pk_bf16_f32 v20, v52, v53
  v_cvt_pk_bf16_f32 v21, v54, v55
  v_cvt_pk_bf16_f32 v22, v56, v57
  v_cvt_pk_bf16_f32 v23, v58, v59
  v_cvt_pk_bf16_f32 v24, v60, v61
  v_cvt_pk_bf16_f32 v25, v62, v63
  v_cvt_pk_bf16_f32 v26, v64, v65
  v_cvt_pk_bf16_f32 v27, v66, v67
  buffer_store_dwordx4 v[8:11], v5, s[16:19], 0 offen sc1
  buffer_store_dwordx4 v[12:15], v5, s[16:19], s31 offen sc1
  buffer_store_dwordx4 v[16:19], v5, s[16:19], s32 offen sc1
  buffer_store_dwordx4 v[20:23], v5, s[16:19], s33 offen sc1
  buffer_store_dwordx4 v[24:27], v5, s[16:19], s34 offen sc1
  v_pk_add_f32 v[92:93], v[28:29], v[36:37]
  v_pk_add_f32 v[94:95], v[30:31], v[38:39]
  v_pk_add_f32 v[96:97], v[32:33], v[40:41]
  v_pk_add_f32 v[98:99], v[34:35], v[42:43]
  v_pk_add_f32 v[92:93], v[92:93], v[44:45]
  v_pk_add_f32 v[94:95], v[94:95], v[46:47]
  v_pk_add_f32 v[96:97], v[96:97], v[48:49]
  v_pk_add_f32 v[98:99], v[98:99], v[50:51]
  v_pk_add_f32 v[92:93], v[92:93], v[52:53]
  v_pk_add_f32 v[94:95], v[94:95], v[54:55]
  v_pk_add_f32 v[96:97], v[96:97], v[56:57]
  v_pk_add_f32 v[98:99], v[98:99], v[58:59]
  v_pk_add_f32 v[92:93], v[92:93], v[60:61]
  v_pk_add_f32 v[94:95], v[94:95], v[62:63]
  v_pk_add_f32 v[96:97], v[96:97], v[64:65]
  v_pk_add_f32 v[98:99], v[98:99], v[66:67]
  v_pk_add_f32 v[92:93], v[92:93], v[94:95]
  v_pk_add_f32 v[96:97], v[96:97], v[98:99]
  v_pk_add_f32 v[92:93], v[92:93], v[96:97]
  v_add_f32 v92, v92, v93
  v_pk_mul_f32 v[104:105], v[28:29], v[28:29]
  v_pk_mul_f32 v[106:107], v[30:31], v[30:31]
  v_pk_mul_f32 v[108:109], v[32:33], v[32:33]
  v_pk_mul_f32 v[110:111], v[34:35], v[34:35]
  v_pk_fma_f32 v[104:105], v[36:37], v[36:37], v[104:105]
  v_pk_fma_f32 v[106:107], v[38:39], v[38:39], v[106:107]
  v_pk_fma_f32 v[108:109], v[40:41], v[40:41], v[108:109]
  v_pk_fma_f32 v[110:111], v[42:43], v[42:43], v[110:111]
  v_pk_fma_f32 v[104:105], v[44:45], v[44:45], v[104:105]
  v_pk_fma_f32 v[106:107], v[46:47], v[46:47], v[106:107]
  v_pk_fma_f32 v[108:109], v[48:49], v[48:49], v[108:109]
  v_pk_fma_f32 v[110:111], v[50:51], v[50:51], v[110:111]
  v_pk_fma_f32 v[104:105], v[52:53], v[52:53], v[104:105]
  v_pk_fma_f32 v[106:107], v[54:55], v[54:55], v[106:107]
  v_pk_fma_f32 v[108:109], v[56:57], v[56:57], v[108:109]
  v_pk_fma_f32 v[110:111], v[58:59], v[58:59], v[110:111]
  v_pk_fma_f32 v[104:105], v[60:61], v[60:61], v[104:105]
  v_pk_fma_f32 v[106:107], v[62:63], v[62:63], v[106:107]
  v_pk_fma_f32 v[108:109], v[64:65], v[64:65], v[108:109]
  v_pk_fma_f32 v[110:111], v[66:67], v[66:67], v[110:111]
  v_pk_add_f32 v[104:105], v[104:105], v[106:107]
  v_pk_add_f32 v[108:109], v[108:109], v[110:111]
  v_pk_add_f32 v[104:105], v[104:105], v[108:109]
  v_add_f32 v104, v104, v105
  v_add_f32_dpp v92, v92, v92 row_ror:8 row_mask:0xf bank_mask:0xf
  s_nop 0
  v_add_f32_dpp v104, v104, v104 row_ror:8 row_mask:0xf bank_mask:0xf
  v_add_f32_dpp v92, v92, v92 row_ror:4 row_mask:0xf bank_mask:0xf
  s_nop 0
  v_add_f32_dpp v104, v104, v104 row_ror:4 row_mask:0xf bank_mask:0xf
  v_add_f32_dpp v92, v92, v92 row_ror:2 row_mask:0xf bank_mask:0xf
  s_nop 0
  v_add_f32_dpp v104, v104, v104 row_ror:2 row_mask:0xf bank_mask:0xf
  v_add_f32_dpp v92, v92, v92 row_ror:1 row_mask:0xf bank_mask:0xf
  s_nop 0
  v_add_f32_dpp v104, v104, v104 row_ror:1 row_mask:0xf bank_mask:0xf
  v_mul_f32 v92, v70, v92
  v_fma_f32 v104, v104, v70, v71
  v_fma_f32 v104, -v92, v92, v104
  v_rsq_f32 v102, v104
  s_nop 0
  v_mul_f32 v100, v92, v102
  v_sub_f32 v100, 0, v100
  v_pk_fma_f32 v[28:29], v[28:29], v[102:103], v[100:101] op_sel_hi:[1,0,0]
  v_pk_fma_f32 v[30:31], v[30:31], v[102:103], v[100:101] op_sel_hi:[1,0,0]
  v_pk_fma_f32 v[32:33], v[32:33], v[102:103], v[100:101] op_sel_hi:[1,0,0]
  v_pk_fma_f32 v[34:35], v[34:35], v[102:103], v[100:101] op_sel_hi:[1,0,0]
  v_pk_fma_f32 v[36:37], v[36:37], v[102:103], v[100:101] op_sel_hi:[1,0,0]
  v_pk_fma_f32 v[38:39], v[38:39], v[102:103], v[100:101] op_sel_hi:[1,0,0]
  v_pk_fma_f32 v[40:41], v[40:41], v[102:103], v[100:101] op_sel_hi:[1,0,0]
  v_pk_fma_f32 v[42:43], v[42:43], v[102:103], v[100:101] op_sel_hi:[1,0,0]
  v_pk_fma_f32 v[44:45], v[44:45], v[102:103], v[100:101] op_sel_hi:[1,0,0]
  v_pk_fma_f32 v[46:47], v[46:47], v[102:103], v[100:101] op_sel_hi:[1,0,0]
  v_pk_fma_f32 v[48:49], v[48:49], v[102:103], v[100:101] op_sel_hi:[1,0,0]
  v_pk_fma_f32 v[50:51], v[50:51], v[102:103], v[100:101] op_sel_hi:[1,0,0]
  v_pk_fma_f32 v[52:53], v[52:53], v[102:103], v[100:101] op_sel_hi:[1,0,0]
  v_pk_fma_f32 v[54:55], v[54:55], v[102:103], v[100:101] op_sel_hi:[1,0,0]
  v_pk_fma_f32 v[56:57], v[56:57], v[102:103], v[100:101] op_sel_hi:[1,0,0]
  v_pk_fma_f32 v[58:59], v[58:59], v[102:103], v[100:101] op_sel_hi:[1,0,0]
  v_pk_fma_f32 v[60:61], v[60:61], v[102:103], v[100:101] op_sel_hi:[1,0,0]
  v_pk_fma_f32 v[62:63], v[62:63], v[102:103], v[100:101] op_sel_hi:[1,0,0]
  v_pk_fma_f32 v[64:65], v[64:65], v[102:103], v[100:101] op_sel_hi:[1,0,0]
  v_pk_fma_f32 v[66:67], v[66:67], v[102:103], v[100:101] op_sel_hi:[1,0,0]
  v_cvt_pk_bf16_f32 v72, v28, v29
  v_cvt_pk_bf16_f32 v73, v30, v31
  v_cvt_pk_bf16_f32 v74, v32, v33
  v_cvt_pk_bf16_f32 v75, v34, v35
  v_cvt_pk_bf16_f32 v76, v36, v37
  v_cvt_pk_bf16_f32 v77, v38, v39
  v_cvt_pk_bf16_f32 v78, v40, v41
  v_cvt_pk_bf16_f32 v79, v42, v43
  v_cvt_pk_bf16_f32 v80, v44, v45
  v_cvt_pk_bf16_f32 v81, v46, v47
  v_cvt_pk_bf16_f32 v82, v48, v49
  v_cvt_pk_bf16_f32 v83, v50, v51
  v_cvt_pk_bf16_f32 v84, v52, v53
  v_cvt_pk_bf16_f32 v85, v54, v55
  v_cvt_pk_bf16_f32 v86, v56, v57
  v_cvt_pk_bf16_f32 v87, v58, v59
  v_cvt_pk_bf16_f32 v88, v60, v61
  v_cvt_pk_bf16_f32 v89, v62, v63
  v_cvt_pk_bf16_f32 v90, v64, v65
  v_cvt_pk_bf16_f32 v91, v66, v67
  buffer_store_dwordx4 v[72:75], v112, s[16:19], 0 offen sc1
  buffer_store_dwordx4 v[76:79], v113, s[16:19], 0 offen sc1
  buffer_store_dwordx4 v[80:83], v114, s[16:19], 0 offen sc1
  buffer_store_dwordx4 v[84:87], v115, s[16:19], 0 offen sc1
  buffer_store_dwordx4 v[88:91], v116, s[16:19], 0 offen sc1
  s_waitcnt lgkmcnt(0)
  s_mul_i32 s94, s95, 0x9e3779b1
  s_add_u32 s94, s94, 0x7f4a7c15
  s_lshl_b32 s30, s2, 4
  s_waitcnt vmcnt(0)
  s_mov_b64 exec, 1
  v_mov_b32 v2, 163776
  v_mov_b32 v3, 1
  ds_add_rtn_u32 v3, v2, v3
  s_waitcnt lgkmcnt(0)
  v_readfirstlane_b32 s31, v3
  s_cmp_lg_u32 s31, 1
  s_cbranch_scc1 P0_LNSIG
  s_mov_b64 exec, 255
  v_mul_u32_u24 v2, 4096, v1
  v_mov_b32 v3, s94
  buffer_store_dword v3, v2, s[16:19], s30 offen sc1
P0_LNSIG:
  s_mov_b64 exec, -1
  s_branch P0_DONE
P0_WARM:
  s_add_u32 s49, s2, 0
  s_lshl_b32 s39, s49, 13
  v_lshlrev_b32 v252, 7, v1
  s_mov_b32 s44, s74
  s_and_b32 s45, s75, 0xffff
  s_mov_b32 s46, 2457600
  s_mov_b32 s47, 0x20000
  buffer_load_dword v253, v252, s[44:47], s39 offen
  s_add_u32 s49, s2, 256
  s_lshl_b32 s39, s49, 13
  v_lshlrev_b32 v252, 7, v1
  s_mov_b32 s44, s74
  s_and_b32 s45, s75, 0xffff
  s_mov_b32 s46, 2457600
  s_mov_b32 s47, 0x20000
  buffer_load_dword v253, v252, s[44:47], s39 offen
  v_mov_b32 v6, 163776
  s_mov_b32 s37, 0
P0_WWAIT:
  ds_read_b32 v7, v6
  s_waitcnt lgkmcnt(0)
  v_readfirstlane_b32 s38, v7
  s_add_u32 s37, s37, 1
  s_cmp_ge_u32 s38, 2
  s_cbranch_scc1 P0_WWAIT_OK
  s_cmp_lt_u32 s37, 0x400000
  s_cbranch_scc0 P0_WWAIT_OK
  s_sleep 1
  s_branch P0_WWAIT
P0_WWAIT_OK:
  s_add_u32 s49, s2, 0
  s_lshl_b32 s39, s49, 13
  v_lshlrev_b32 v252, 7, v1
  s_mov_b32 s44, s80
  s_and_b32 s45, s81, 0xffff
  s_mov_b32 s46, 7077888
  s_mov_b32 s47, 0x20000
  buffer_load_dword v253, v252, s[44:47], s39 offen
  s_add_u32 s49, s2, 256
  s_lshl_b32 s39, s49, 13
  v_lshlrev_b32 v252, 7, v1
  s_mov_b32 s44, s80
  s_and_b32 s45, s81, 0xffff
  s_mov_b32 s46, 7077888
  s_mov_b32 s47, 0x20000
  buffer_load_dword v253, v252, s[44:47], s39 offen
  s_add_u32 s49, s2, 512
  s_lshl_b32 s39, s49, 13
  v_lshlrev_b32 v252, 7, v1
  s_mov_b32 s44, s80
  s_and_b32 s45, s81, 0xffff
  s_mov_b32 s46, 7077888
  s_mov_b32 s47, 0x20000
  buffer_load_dword v253, v252, s[44:47], s39 offen
  s_add_u32 s49, s2, 768
  s_lshl_b32 s39, s49, 13
  v_lshlrev_b32 v252, 7, v1
  s_mov_b32 s44, s80
  s_and_b32 s45, s81, 0xffff
  s_mov_b32 s46, 7077888
  s_mov_b32 s47, 0x20000
  buffer_load_dword v253, v252, s[44:47], s39 offen
  s_branch P0_DONE
P0_WO:
  s_cmp_lt_u32 s2, 96
  s_cbranch_scc1 P0_DONE
  v_mov_b32 v6, 163776
  s_mov_b32 s37, 0
P0_OWAIT:
  ds_read_b32 v7, v6
  s_waitcnt lgkmcnt(0)
  v_readfirstlane_b32 s38, v7
  s_add_u32 s37, s37, 1
  s_cmp_ge_u32 s38, 2
  s_cbranch_scc1 P0_OWAIT_OK
  s_cmp_lt_u32 s37, 0x400000
  s_cbranch_scc0 P0_OWAIT_OK
  s_sleep 1
  s_branch P0_OWAIT
P0_OWAIT_OK:
  s_sub_u32 s25, s2, 96
  s_and_b32 s26, s25, 7
  s_lshr_b32 s27, s25, 3
  s_mul_i32 s28, s27, 52
  s_lshr_b32 s28, s28, 8
  s_mul_i32 s29, s28, 5
  s_sub_u32 s29, s27, s29
  s_mul_i32 s30, s28, 160
  s_mul_i32 s31, s29, 40
  s_add_u32 s31, s31, s30
  s_add_u32 s30, s30, 16
  s_cmp_eq_u32 s29, 4
  s_cselect_b32 s30, s30, s31
  s_cselect_b32 s31, 80, 20
  s_cselect_b32 s32, 20, 4
  s_mov_b32 s20, s76
  s_and_b32 s21, s77, 0xffff
  s_mov_b32 s22, 819200
  s_mov_b32 s23, 0x20000
  s_mul_i32 s33, s26, 160
  s_movk_i32 s35, 1280
  v_add_u32 v2, 0, v1
  v_mul_u32_u24 v3, 6554, v2
  v_lshrrev_b32 v3, 16, v3
  v_mul_u32_u24 v4, 10, v3
  v_sub_u32 v4, v2, v4
  v_lshrrev_b32 v5, 4, v3
  v_mul_lo_u32 v5, v5, s31
  v_bfe_u32 v6, v3, 2, 2
  v_mul_lo_u32 v6, v6, s32
  v_and_b32 v7, 3, v3
  v_add3_u32 v5, v5, v6, v7
  v_add_u32 v5, s30, v5
  v_mul_lo_u32 v5, v5, s35
  v_lshl_add_u32 v5, v4, 4, v5
  s_mov_b32 m0, 158656
  s_nop 0
  buffer_load_dwordx4 v5, s[20:23], s33 offen lds
  v_add_u32 v2, 64, v1
  v_mul_u32_u24 v3, 6554, v2
  v_lshrrev_b32 v3, 16, v3
  v_mul_u32_u24 v4, 10, v3
  v_sub_u32 v4, v2, v4
  v_lshrrev_b32 v5, 4, v3
  v_mul_lo_u32 v5, v5, s31
  v_bfe_u32 v6, v3, 2, 2
  v_mul_lo_u32 v6, v6, s32
  v_and_b32 v7, 3, v3
  v_add3_u32 v5, v5, v6, v7
  v_add_u32 v5, s30, v5
  v_mul_lo_u32 v5, v5, s35
  v_lshl_add_u32 v5, v4, 4, v5
  s_mov_b32 m0, 159680
  s_nop 0
  buffer_load_dwordx4 v5, s[20:23], s33 offen lds
  v_add_u32 v2, 128, v1
  v_mul_u32_u24 v3, 6554, v2
  v_lshrrev_b32 v3, 16, v3
  v_mul_u32_u24 v4, 10, v3
  v_sub_u32 v4, v2, v4
  v_lshrrev_b32 v5, 4, v3
  v_mul_lo_u32 v5, v5, s31
  v_bfe_u32 v6, v3, 2, 2
  v_mul_lo_u32 v6, v6, s32
  v_and_b32 v7, 3, v3
  v_add3_u32 v5, v5, v6, v7
  v_add_u32 v5, s30, v5
  v_mul_lo_u32 v5, v5, s35
  v_lshl_add_u32 v5, v4, 4, v5
  s_mov_b32 m0, 160704
  s_nop 0
  buffer_load_dwordx4 v5, s[20:23], s33 offen lds
  v_add_u32 v2, 192, v1
  v_mul_u32_u24 v3, 6554, v2
  v_lshrrev_b32 v3, 16, v3
  v_mul_u32_u24 v4, 10, v3
  v_sub_u32 v4, v2, v4
  v_lshrrev_b32 v5, 4, v3
  v_mul_lo_u32 v5, v5, s31
  v_bfe_u32 v6, v3, 2, 2
  v_mul_lo_u32 v6, v6, s32
  v_and_b32 v7, 3, v3
  v_add3_u32 v5, v5, v6, v7
  v_add_u32 v5, s30, v5
  v_mul_lo_u32 v5, v5, s35
  v_lshl_add_u32 v5, v4, 4, v5
  s_mov_b32 m0, 161728
  s_nop 0
  buffer_load_dwordx4 v5, s[20:23], s33 offen lds
  v_add_u32 v2, 256, v1
  v_mul_u32_u24 v3, 6554, v2
  v_lshrrev_b32 v3, 16, v3
  v_mul_u32_u24 v4, 10, v3
  v_sub_u32 v4, v2, v4
  v_lshrrev_b32 v5, 4, v3
  v_mul_lo_u32 v5, v5, s31
  v_bfe_u32 v6, v3, 2, 2
  v_mul_lo_u32 v6, v6, s32
  v_and_b32 v7, 3, v3
  v_add3_u32 v5, v5, v6, v7
  v_add_u32 v5, s30, v5
  v_mul_lo_u32 v5, v5, s35
  v_lshl_add_u32 v5, v4, 4, v5
  s_mov_b32 m0, 162752
  s_nop 0
  buffer_load_dwordx4 v5, s[20:23], s33 offen lds
  v_lshrrev_b32 v2, 2, v1
  v_mul_u32_u24 v2, 160, v2
  v_and_b32 v3, 3, v1
  v_lshl_add_u32 v2, v3, 3, v2
  v_add_u32 v2, 158656, v2
  v_lshlrev_b32 v3, 4, v1
  s_mul_i32 s36, s26, 20
  s_add_u32 s36, s36, s27
  s_mul_i32 s36, s36, 5120
  s_add_u32 s36, s36, 5308416
  s_waitcnt vmcnt(0)
  ds_read_b64_tr_b16 v[8:9], v2 offset:0
  ds_read_b64_tr_b16 v[10:11], v2 offset:2560
  ds_read_b64_tr_b16 v[12:13], v2 offset:32
  ds_read_b64_tr_b16 v[14:15], v2 offset:2592
  ds_read_b64_tr_b16 v[16:17], v2 offset:64
  ds_read_b64_tr_b16 v[18:19], v2 offset:2624
  ds_read_b64_tr_b16 v[20:21], v2 offset:96
  ds_read_b64_tr_b16 v[22:23], v2 offset:2656
  ds_read_b64_tr_b16 v[24:25], v2 offset:128
  ds_read_b64_tr_b16 v[26:27], v2 offset:2688
  s_waitcnt lgkmcnt(8)
  buffer_store_dwordx4 v[8:11], v3, s[16:19], s36 offen offset:0 sc1
  s_waitcnt lgkmcnt(6)
  buffer_store_dwordx4 v[12:15], v3, s[16:19], s36 offen offset:1024 sc1
  s_waitcnt lgkmcnt(4)
  buffer_store_dwordx4 v[16:19], v3, s[16:19], s36 offen offset:2048 sc1
  s_waitcnt lgkmcnt(2)
  buffer_store_dwordx4 v[20:23], v3, s[16:19], s36 offen offset:3072 sc1
  s_waitcnt lgkmcnt(0)
  s_add_u32 s36, s36, 4096
  buffer_store_dwordx4 v[24:27], v3, s[16:19], s36 offen offset:0 sc1
  s_waitcnt lgkmcnt(0)
  s_mul_i32 s94, s95, 0x9e3779b1
  s_add_u32 s94, s94, 0x7f4a7c15
  s_lshl_b32 s30, s26, 5
  s_add_u32 s30, s30, s27
  s_lshl_b32 s30, s30, 4
  s_add_u32 s30, s30, 32768
  s_waitcnt vmcnt(0)
  s_mov_b64 exec, 1
  v_mov_b32 v2, 0
  v_mov_b32 v3, s94
  buffer_store_dword v3, v2, s[16:19], s30 offen sc1
  s_mov_b64 exec, -1
  s_branch P0_DONE
P0_DONE:
  s_waitcnt lgkmcnt(0)
  s_mul_i32 s94, s95, 0x9e3779b1
  s_add_u32 s94, s94, 0x7f4a7c15
  s_mov_b32 s50, 4
  s_and_b32 s27, s2, 7
  s_lshr_b32 s28, s2, 3
  s_cmp_ge_u32 s27, 4
  s_cbranch_scc1 P1_ISU
  s_lshr_b32 s25, s27, 1
  s_lshl_b32 s25, s25, 3
  s_and_b32 s29, s28, 7
  s_add_u32 s25, s25, s29
  s_and_b32 s26, s27, 1
  s_lshl_b32 s26, s26, 2
  s_lshr_b32 s29, s28, 3
  s_add_u32 s26, s26, s29
  s_cmp_lt_u32 s24, 4
  s_cbranch_scc1 P1_QC
  s_branch P1_QL
P1_ISU:
  s_sub_u32 s29, s27, 4
  s_cmp_ge_u32 s28, 28
  s_cbranch_scc1 P1_IDLE
  s_mul_i32 s26, s29, 3
  s_lshr_b32 s30, s28, 3
  s_add_u32 s26, s26, s30
  s_and_b32 s25, s28, 7
  s_cmp_lt_u32 s28, 24
  s_cbranch_scc1 P1_ISU2
  s_lshr_b32 s26, s29, 1
  s_add_u32 s26, s26, 12
  s_and_b32 s25, s29, 1
  s_lshl_b32 s25, s25, 2
  s_and_b32 s30, s28, 3
  s_add_u32 s25, s25, s30
  s_branch P1_ISU2
P1_IDLE:
  s_mov_b32 s44, s84
  s_and_b32 s45, s85, 0xffff
  s_mov_b32 s46, 7077888
  s_mov_b32 s47, 0x20000
  s_lshl_b32 s29, s29, 2
  s_and_b32 s30, s28, 3
  s_add_u32 s29, s29, s30
  s_lshl_b32 s29, s29, 3
  s_add_u32 s29, s29, s24
  s_lshl_b32 s39, s29, 13
  v_lshlrev_b32 v252, 7, v1
  buffer_load_dword v253, v252, s[44:47], s39 offen
  s_add_u32 s39, s39, 1048576
  buffer_load_dword v253, v252, s[44:47], s39 offen
  s_add_u32 s39, s39, 1048576
  s_waitcnt vmcnt(1)
  buffer_load_dword v253, v252, s[44:47], s39 offen
  s_add_u32 s39, s39, 1048576
  s_waitcnt vmcnt(1)
  buffer_load_dword v253, v252, s[44:47], s39 offen
  s_add_u32 s39, s39, 1048576
  s_waitcnt vmcnt(1)
  buffer_load_dword v253, v252, s[44:47], s39 offen
  s_add_u32 s39, s39, 1048576
  s_waitcnt vmcnt(1)
  buffer_load_dword v253, v252, s[44:47], s39 offen
  s_add_u32 s39, s39, 1048576
  s_waitcnt vmcnt(1)
  buffer_load_dword v253, v252, s[44:47], s39 offen
  s_add_u32 s39, s39, 1048576
  s_waitcnt vmcnt(0)
  s_mov_b32 s50, 0
  s_barrier
  s_branch P3_ENTRY
P1_ISU2:
  s_cmp_lt_u32 s24, 4
  s_cbranch_scc1 P1_UC
P1_UL:
  s_mov_b32 s20, s80
  s_and_b32 s21, s81, 0xffff
  s_mov_b32 s22, 7077888
  s_mov_b32 s23, 0x20000
  v_lshlrev_b32 v2, 4, v1
  v_lshrrev_b32 v3, 3, v1
  v_bfe_u32 v4, v1, 4, 2
  v_lshlrev_b32 v4, 1, v4
  v_and_b32 v5, 7, v1
  v_xor_b32 v4, v4, v5
  v_lshlrev_b32 v4, 4, v4
  v_mul_u32_u24 v3, 3456, v3
  v_add_u32 v3, v3, v4
  s_mul_i32 s30, s25, 327680
  s_add_u32 s30, s30, 2686976
  s_lshl_b32 s31, s26, 8
  s_waitcnt lgkmcnt(0)
  s_mul_i32 s94, s95, 0x9e3779b1
  s_add_u32 s94, s94, 0x7f4a7c15
  s_cmp_lg_u32 s24, 4
  s_cbranch_scc1 P1_UL0_NEXT
  s_and_b32 s40, s2, 7
  s_lshl_b32 s40, s40, 12
  v_min_u32 v6, 23, v1
  v_lshlrev_b32 v6, 4, v6
  s_mov_b32 s37, 0
P1_UPOLL:
  buffer_load_dword v8, v6, s[16:19], s40 offen sc1
  s_waitcnt vmcnt(0)
  v_cmp_ne_u32 vcc, s94, v8
  s_add_u32 s37, s37, 1
  s_cmp_eq_u64 vcc, 0
  s_cbranch_scc1 P1_UPOLL_OK
  s_cmp_lt_u32 s37, 0x8000
  s_cbranch_scc0 P1_UPOLL_OK
  s_sleep 2
  s_branch P1_UPOLL
P1_UPOLL_OK:
  v_mov_b32 v6, 163784
  v_mov_b32 v7, 1
  ds_write_b32 v6, v7
  s_waitcnt lgkmcnt(0)
  s_mov_b32 s34, 0
  s_mov_b32 s36, 3
P1_UL0_S_0:
  s_add_u32 m0, s34, 16384
  s_nop 0
  buffer_load_dwordx4 v2, s[16:19], s30 offen sc1 lds
  s_add_u32 m0, s34, 17408
  s_add_u32 s35, s30, 1024
  buffer_load_dwordx4 v2, s[16:19], s35 offen sc1 lds
  s_add_u32 m0, s34, 18432
  s_add_u32 s35, s30, 2048
  buffer_load_dwordx4 v2, s[16:19], s35 offen sc1 lds
  s_add_u32 m0, s34, 19456
  s_add_u32 s35, s30, 3072
  buffer_load_dwordx4 v2, s[16:19], s35 offen sc1 lds
  s_add_u32 m0, s34, 20480
  s_add_u32 s35, s30, 4096
  buffer_load_dwordx4 v2, s[16:19], s35 offen sc1 lds
  s_add_u32 s30, s30, 10240
  s_add_u32 s31, s31, 221184
  s_add_u32 s34, s34, 26624
  s_cmp_eq_u32 s34, 106496
  s_cselect_b32 s34, 0, s34
  s_sub_u32 s36, s36, 1
  s_cmp_lg_u32 s36, 0
  s_cbranch_scc1 P1_UL0_S_0
  s_mov_b32 s36, 29
P1_UL0_S_1:
  s_waitcnt vmcnt(10)
  s_barrier
  s_add_u32 m0, s34, 16384
  s_nop 0
  buffer_load_dwordx4 v2, s[16:19], s30 offen sc1 lds
  s_add_u32 m0, s34, 17408
  s_add_u32 s35, s30, 1024
  buffer_load_dwordx4 v2, s[16:19], s35 offen sc1 lds
  s_add_u32 m0, s34, 18432
  s_add_u32 s35, s30, 2048
  buffer_load_dwordx4 v2, s[16:19], s35 offen sc1 lds
  s_add_u32 m0, s34, 19456
  s_add_u32 s35, s30, 3072
  buffer_load_dwordx4 v2, s[16:19], s35 offen sc1 lds
  s_add_u32 m0, s34, 20480
  s_add_u32 s35, s30, 4096
  buffer_load_dwordx4 v2, s[16:19], s35 offen sc1 lds
  s_add_u32 s30, s30, 10240
  s_add_u32 s31, s31, 221184
  s_add_u32 s34, s34, 26624
  s_cmp_eq_u32 s34, 106496
  s_cselect_b32 s34, 0, s34
  s_sub_u32 s36, s36, 1
  s_cmp_lg_u32 s36, 0
  s_cbranch_scc1 P1_UL0_S_1
  s_waitcnt vmcnt(10)
  s_barrier
  s_waitcnt vmcnt(5)
  s_barrier
  s_waitcnt vmcnt(0)
  s_barrier
  s_mov_b32 s44, s84
  s_and_b32 s45, s85, 0xffff
  s_mov_b32 s46, 7077888
  s_mov_b32 s47, 0x20000
  s_lshr_b32 s38, s2, 3
  s_cmp_ge_u32 s38, 27
  s_cbranch_scc1 P1_NOPF861
  s_cmp_lg_u32 s24, 4
  s_cbranch_scc1 P1_NOPF861
  s_mul_i32 s38, s38, 262144
  s_lshr_b32 s39, s84, 7
  s_sub_u32 s39, 3, s39
  s_and_b32 s39, s39, 7
  s_lshl_b32 s39, s39, 7
  s_add_u32 s38, s38, s39
  s_and_b32 s39, s2, 7
  s_lshr_b32 s39, s39, 1
  s_lshl_b32 s39, s39, 10
  s_add_u32 s38, s38, s39
  v_lshlrev_b32 v252, 12, v1
  buffer_load_dword v253, v252, s[44:47], s38 offen
P1_NOPF861:
  s_barrier
  s_branch P3_ENTRY
P1_UL0_NEXT:
  s_cmp_lg_u32 s24, 5
  s_cbranch_scc1 P1_UL1_NEXT
  v_mov_b32 v6, 163784
  s_mov_b32 s37, 0
P1_UGOA1:
  ds_read_b32 v7, v6
  s_waitcnt lgkmcnt(0)
  v_readfirstlane_b32 s38, v7
  s_add_u32 s37, s37, 1
  s_cmp_ge_u32 s38, 1
  s_cbranch_scc1 P1_UGOA1_OK
  s_cmp_lt_u32 s37, 0x400000
  s_cbranch_scc0 P1_UGOA1_OK
  s_sleep 1
  s_branch P1_UGOA1
P1_UGOA1_OK:
  s_mov_b32 s34, 0
  s_mov_b32 s36, 3
P1_UL1_S_0:
  s_add_u32 m0, s34, 21504
  s_add_u32 s35, s30, 5120
  buffer_load_dwordx4 v2, s[16:19], s35 offen sc1 lds
  s_add_u32 m0, s34, 22528
  s_add_u32 s35, s30, 6144
  buffer_load_dwordx4 v2, s[16:19], s35 offen sc1 lds
  s_add_u32 m0, s34, 23552
  s_add_u32 s35, s30, 7168
  buffer_load_dwordx4 v2, s[16:19], s35 offen sc1 lds
  s_add_u32 m0, s34, 24576
  s_add_u32 s35, s30, 8192
  buffer_load_dwordx4 v2, s[16:19], s35 offen sc1 lds
  s_add_u32 m0, s34, 25600
  s_add_u32 s35, s30, 9216
  buffer_load_dwordx4 v2, s[16:19], s35 offen sc1 lds
  s_add_u32 s30, s30, 10240
  s_add_u32 s31, s31, 221184
  s_add_u32 s34, s34, 26624
  s_cmp_eq_u32 s34, 106496
  s_cselect_b32 s34, 0, s34
  s_sub_u32 s36, s36, 1
  s_cmp_lg_u32 s36, 0
  s_cbranch_scc1 P1_UL1_S_0
  s_mov_b32 s36, 29
P1_UL1_S_1:
  s_waitcnt vmcnt(10)
  s_barrier
  s_add_u32 m0, s34, 21504
  s_add_u32 s35, s30, 5120
  buffer_load_dwordx4 v2, s[16:19], s35 offen sc1 lds
  s_add_u32 m0, s34, 22528
  s_add_u32 s35, s30, 6144
  buffer_load_dwordx4 v2, s[16:19], s35 offen sc1 lds
  s_add_u32 m0, s34, 23552
  s_add_u32 s35, s30, 7168
  buffer_load_dwordx4 v2, s[16:19], s35 offen sc1 lds
  s_add_u32 m0, s34, 24576
  s_add_u32 s35, s30, 8192
  buffer_load_dwordx4 v2, s[16:19], s35 offen sc1 lds
  s_add_u32 m0, s34, 25600
  s_add_u32 s35, s30, 9216
  buffer_load_dwordx4 v2, s[16:19], s35 offen sc1 lds
  s_add_u32 s30, s30, 10240
  s_add_u32 s31, s31, 221184
  s_add_u32 s34, s34, 26624
  s_cmp_eq_u32 s34, 106496
  s_cselect_b32 s34, 0, s34
  s_sub_u32 s36, s36, 1
  s_cmp_lg_u32 s36, 0
  s_cbranch_scc1 P1_UL1_S_1
  s_waitcnt vmcnt(10)
  s_barrier
  s_waitcnt vmcnt(5)
  s_barrier
  s_waitcnt vmcnt(0)
  s_barrier
  s_mov_b32 s44, s84
  s_and_b32 s45, s85, 0xffff
  s_mov_b32 s46, 7077888
  s_mov_b32 s47, 0x20000
  s_lshr_b32 s38, s2, 3
  s_cmp_ge_u32 s38, 27
  s_cbranch_scc1 P1_NOPF961
  s_cmp_lg_u32 s24, 4
  s_cbranch_scc1 P1_NOPF961
  s_mul_i32 s38, s38, 262144
  s_lshr_b32 s39, s84, 7
  s_sub_u32 s39, 3, s39
  s_and_b32 s39, s39, 7
  s_lshl_b32 s39, s39, 7
  s_add_u32 s38, s38, s39
  s_and_b32 s39, s2, 7
  s_lshr_b32 s39, s39, 1
  s_lshl_b32 s39, s39, 10
  s_add_u32 s38, s38, s39
  v_lshlrev_b32 v252, 12, v1
  buffer_load_dword v253, v252, s[44:47], s38 offen
P1_NOPF961:
  s_barrier
  s_branch P3_ENTRY
P1_UL1_NEXT:
  s_cmp_lg_u32 s24, 6
  s_cbranch_scc1 P1_UL2_NEXT
  s_mov_b32 s34, 0
  s_mov_b32 s36, 3
P1_UL2_S_0:
  s_add_u32 m0, s34, 0
  s_nop 0
  buffer_load_dwordx4 v3, s[20:23], s31 offen  lds
  s_add_u32 m0, s34, 1024
  s_add_u32 s35, s31, 27648
  buffer_load_dwordx4 v3, s[20:23], s35 offen  lds
  s_add_u32 m0, s34, 2048
  s_add_u32 s35, s31, 55296
  buffer_load_dwordx4 v3, s[20:23], s35 offen  lds
  s_add_u32 m0, s34, 3072
  s_add_u32 s35, s31, 82944
  buffer_load_dwordx4 v3, s[20:23], s35 offen  lds
  s_add_u32 m0, s34, 4096
  s_add_u32 s35, s31, 110592
  buffer_load_dwordx4 v3, s[20:23], s35 offen  lds
  s_add_u32 m0, s34, 5120
  s_add_u32 s35, s31, 138240
  buffer_load_dwordx4 v3, s[20:23], s35 offen  lds
  s_add_u32 m0, s34, 6144
  s_add_u32 s35, s31, 165888
  buffer_load_dwordx4 v3, s[20:23], s35 offen  lds
  s_add_u32 m0, s34, 7168
  s_add_u32 s35, s31, 193536
  buffer_load_dwordx4 v3, s[20:23], s35 offen  lds
  s_add_u32 s30, s30, 10240
  s_add_u32 s31, s31, 221184
  s_add_u32 s34, s34, 26624
  s_cmp_eq_u32 s34, 106496
  s_cselect_b32 s34, 0, s34
  s_sub_u32 s36, s36, 1
  s_cmp_lg_u32 s36, 0
  s_cbranch_scc1 P1_UL2_S_0
  s_mov_b32 s36, 29
P1_UL2_S_1:
  s_waitcnt vmcnt(16)
  s_barrier
  s_add_u32 m0, s34, 0
  s_nop 0
  buffer_load_dwordx4 v3, s[20:23], s31 offen  lds
  s_add_u32 m0, s34, 1024
  s_add_u32 s35, s31, 27648
  buffer_load_dwordx4 v3, s[20:23], s35 offen  lds
  s_add_u32 m0, s34, 2048
  s_add_u32 s35, s31, 55296
  buffer_load_dwordx4 v3, s[20:23], s35 offen  lds
  s_add_u32 m0, s34, 3072
  s_add_u32 s35, s31, 82944
  buffer_load_dwordx4 v3, s[20:23], s35 offen  lds
  s_add_u32 m0, s34, 4096
  s_add_u32 s35, s31, 110592
  buffer_load_dwordx4 v3, s[20:23], s35 offen  lds
  s_add_u32 m0, s34, 5120
  s_add_u32 s35, s31, 138240
  buffer_load_dwordx4 v3, s[20:23], s35 offen  lds
  s_add_u32 m0, s34, 6144
  s_add_u32 s35, s31, 165888
  buffer_load_dwordx4 v3, s[20:23], s35 offen  lds
  s_add_u32 m0, s34, 7168
  s_add_u32 s35, s31, 193536
  buffer_load_dwordx4 v3, s[20:23], s35 offen  lds
  s_add_u32 s30, s30, 10240
  s_add_u32 s31, s31, 221184
  s_add_u32 s34, s34, 26624
  s_cmp_eq_u32 s34, 106496
  s_cselect_b32 s34, 0, s34
  s_sub_u32 s36, s36, 1
  s_cmp_lg_u32 s36, 0
  s_cbranch_scc1 P1_UL2_S_1
  s_waitcnt vmcnt(16)
  s_barrier
  s_waitcnt vmcnt(8)
  s_barrier
  s_waitcnt vmcnt(0)
  s_barrier
  s_mov_b32 s44, s84
  s_and_b32 s45, s85, 0xffff
  s_mov_b32 s46, 7077888
  s_mov_b32 s47, 0x20000
  s_lshr_b32 s38, s2, 3
  s_cmp_ge_u32 s38, 27
  s_cbranch_scc1 P1_NOPF1065
  s_cmp_lg_u32 s24, 4
  s_cbranch_scc1 P1_NOPF1065
  s_mul_i32 s38, s38, 262144
  s_lshr_b32 s39, s84, 7
  s_sub_u32 s39, 3, s39
  s_and_b32 s39, s39, 7
  s_lshl_b32 s39, s39, 7
  s_add_u32 s38, s38, s39
  s_and_b32 s39, s2, 7
  s_lshr_b32 s39, s39, 1
  s_lshl_b32 s39, s39, 10
  s_add_u32 s38, s38, s39
  v_lshlrev_b32 v252, 12, v1
  buffer_load_dword v253, v252, s[44:47], s38 offen
P1_NOPF1065:
  s_barrier
  s_branch P3_ENTRY
P1_UL2_NEXT:
  s_mov_b32 s34, 0
  s_mov_b32 s36, 3
P1_UL3_S_0:
  s_add_u32 m0, s34, 8192
  s_add_u32 s35, s31, 128
  buffer_load_dwordx4 v3, s[20:23], s35 offen  lds
  s_add_u32 m0, s34, 9216
  s_add_u32 s35, s31, 27776
  buffer_load_dwordx4 v3, s[20:23], s35 offen  lds
  s_add_u32 m0, s34, 10240
  s_add_u32 s35, s31, 55424
  buffer_load_dwordx4 v3, s[20:23], s35 offen  lds
  s_add_u32 m0, s34, 11264
  s_add_u32 s35, s31, 83072
  buffer_load_dwordx4 v3, s[20:23], s35 offen  lds
  s_add_u32 m0, s34, 12288
  s_add_u32 s35, s31, 110720
  buffer_load_dwordx4 v3, s[20:23], s35 offen  lds
  s_add_u32 m0, s34, 13312
  s_add_u32 s35, s31, 138368
  buffer_load_dwordx4 v3, s[20:23], s35 offen  lds
  s_add_u32 m0, s34, 14336
  s_add_u32 s35, s31, 166016
  buffer_load_dwordx4 v3, s[20:23], s35 offen  lds
  s_add_u32 m0, s34, 15360
  s_add_u32 s35, s31, 193664
  buffer_load_dwordx4 v3, s[20:23], s35 offen  lds
  s_add_u32 s30, s30, 10240
  s_add_u32 s31, s31, 221184
  s_add_u32 s34, s34, 26624
  s_cmp_eq_u32 s34, 106496
  s_cselect_b32 s34, 0, s34
  s_sub_u32 s36, s36, 1
  s_cmp_lg_u32 s36, 0
  s_cbranch_scc1 P1_UL3_S_0
  s_mov_b32 s36, 29
P1_UL3_S_1:
  s_waitcnt vmcnt(16)
  s_barrier
  s_add_u32 m0, s34, 8192
  s_add_u32 s35, s31, 128
  buffer_load_dwordx4 v3, s[20:23], s35 offen  lds
  s_add_u32 m0, s34, 9216
  s_add_u32 s35, s31, 27776
  buffer_load_dwordx4 v3, s[20:23], s35 offen  lds
  s_add_u32 m0, s34, 10240
  s_add_u32 s35, s31, 55424
  buffer_load_dwordx4 v3, s[20:23], s35 offen  lds
  s_add_u32 m0, s34, 11264
  s_add_u32 s35, s31, 83072
  buffer_load_dwordx4 v3, s[20:23], s35 offen  lds
  s_add_u32 m0, s34, 12288
  s_add_u32 s35, s31, 110720
  buffer_load_dwordx4 v3, s[20:23], s35 offen  lds
  s_add_u32 m0, s34, 13312
  s_add_u32 s35, s31, 138368
  buffer_load_dwordx4 v3, s[20:23], s35 offen  lds
  s_add_u32 m0, s34, 14336
  s_add_u32 s35, s31, 166016
  buffer_load_dwordx4 v3, s[20:23], s35 offen  lds
  s_add_u32 m0, s34, 15360
  s_add_u32 s35, s31, 193664
  buffer_load_dwordx4 v3, s[20:23], s35 offen  lds
  s_add_u32 s30, s30, 10240
  s_add_u32 s31, s31, 221184
  s_add_u32 s34, s34, 26624
  s_cmp_eq_u32 s34, 106496
  s_cselect_b32 s34, 0, s34
  s_sub_u32 s36, s36, 1
  s_cmp_lg_u32 s36, 0
  s_cbranch_scc1 P1_UL3_S_1
  s_waitcnt vmcnt(16)
  s_barrier
  s_waitcnt vmcnt(8)
  s_barrier
  s_waitcnt vmcnt(0)
  s_barrier
  s_mov_b32 s44, s84
  s_and_b32 s45, s85, 0xffff
  s_mov_b32 s46, 7077888
  s_mov_b32 s47, 0x20000
  s_lshr_b32 s38, s2, 3
  s_cmp_ge_u32 s38, 27
  s_cbranch_scc1 P1_NOPF1167
  s_cmp_lg_u32 s24, 4
  s_cbranch_scc1 P1_NOPF1167
  s_mul_i32 s38, s38, 262144
  s_lshr_b32 s39, s84, 7
  s_sub_u32 s39, 3, s39
  s_and_b32 s39, s39, 7
  s_lshl_b32 s39, s39, 7
  s_add_u32 s38, s38, s39
  s_and_b32 s39, s2, 7
  s_lshr_b32 s39, s39, 1
  s_lshl_b32 s39, s39, 10
  s_add_u32 s38, s38, s39
  v_lshlrev_b32 v252, 12, v1
  buffer_load_dword v253, v252, s[44:47], s38 offen
P1_NOPF1167:
  s_barrier
  s_branch P3_ENTRY
P1_UC:
  s_mov_b32 s20, s82
  s_and_b32 s21, s83, 0xffff
  s_mov_b32 s22, 3456
  s_mov_b32 s23, 0x20000
  v_lshrrev_b32 v5, 4, v1
  v_lshlrev_b32 v5, 3, v5
  s_lshl_b32 s30, s26, 8
  s_lshl_b32 s31, s24, 6
  s_add_u32 s30, s30, s31
  buffer_load_dwordx2 v[116:117], v5, s[20:23], s30 offen
  buffer_load_dwordx2 v[118:119], v5, s[20:23], s30 offen offset:32
  v_lshrrev_b32 v7, 2, v1
  v_bfe_u32 v5, v1, 3, 2
  s_and_b32 s30, s24, 1
  s_lshl_b32 s30, s30, 1
  v_xor_b32 v5, s30, v5
  v_lshlrev_b32 v5, 5, v5
  v_lshl_add_u32 v5, v7, 7, v5
  v_and_b32 v6, 3, v1
  v_lshl_add_u32 v5, v6, 3, v5
  s_lshr_b32 s30, s24, 1
  s_lshl_b32 s30, s30, 13
  v_add_u32 v2, s30, v5
  v_xor_b32 v3, 32, v2
  v_mul_u32_u24 v7, 160, v7
  v_lshl_add_u32 v4, v6, 3, v7
  v_mov_b32 v8, 0
  v_mov_b32 v9, 0
  v_mov_b32 v10, 0
  v_mov_b32 v11, 0
  v_mov_b32 v12, 0
  v_mov_b32 v13, 0
  v_mov_b32 v14, 0
  v_mov_b32 v15, 0
  v_mov_b32 v16, 0
  v_mov_b32 v17, 0
  v_mov_b32 v18, 0
  v_mov_b32 v19, 0
  v_mov_b32 v20, 0
  v_mov_b32 v21, 0
  v_mov_b32 v22, 0
  v_mov_b32 v23, 0
  v_mov_b32 v24, 0
  v_mov_b32 v25, 0
  v_mov_b32 v26, 0
  v_mov_b32 v27, 0
  v_mov_b32 v28, 0
  v_mov_b32 v29, 0
  v_mov_b32 v30, 0
  v_mov_b32 v31, 0
  v_mov_b32 v32, 0
  v_mov_b32 v33, 0
  v_mov_b32 v34, 0
  v_mov_b32 v35, 0
  v_mov_b32 v36, 0
  v_mov_b32 v37, 0
  v_mov_b32 v38, 0
  v_mov_b32 v39, 0
  v_mov_b32 v40, 0
  v_mov_b32 v41, 0
  v_mov_b32 v42, 0
  v_mov_b32 v43, 0
  v_mov_b32 v44, 0
  v_mov_b32 v45, 0
  v_mov_b32 v46, 0
  v_mov_b32 v47, 0
  v_mov_b32 v76, 0
  v_mov_b32 v77, 0
  v_mov_b32 v78, 0
  v_mov_b32 v79, 0
  v_mov_b32 v80, 0
  v_mov_b32 v81, 0
  v_mov_b32 v82, 0
  v_mov_b32 v83, 0
  v_mov_b32 v84, 0
  v_mov_b32 v85, 0
  v_mov_b32 v86, 0
  v_mov_b32 v87, 0
  v_mov_b32 v88, 0
  v_mov_b32 v89, 0
  v_mov_b32 v90, 0
  v_mov_b32 v91, 0
  v_mov_b32 v92, 0
  v_mov_b32 v93, 0
  v_mov_b32 v94, 0
  v_mov_b32 v95, 0
  v_mov_b32 v96, 0
  v_mov_b32 v97, 0
  v_mov_b32 v98, 0
  v_mov_b32 v99, 0
  v_mov_b32 v100, 0
  v_mov_b32 v101, 0
  v_mov_b32 v102, 0
  v_mov_b32 v103, 0
  s_mov_b32 s34, 0
  s_mov_b32 s33, 16384
  s_mov_b32 s35, 32
  v_add_u32 v4, 16384, v4
  s_cmp_lg_u32 s24, 1
  s_cbranch_scc1 P1_UC_NOPOLL
  v_lshlrev_b32 v6, 4, v1
  s_and_b32 s40, s2, 7
  s_lshl_b32 s40, s40, 12
  s_add_u32 s41, s40, 1024
  s_add_u32 s42, s40, 2048
  s_add_u32 s43, s40, 3072
  s_mov_b32 s37, 0
P1_UCPOLL:
  buffer_load_dword v130, v6, s[16:19], s40 offen sc1
  buffer_load_dword v131, v6, s[16:19], s41 offen sc1
  buffer_load_dword v132, v6, s[16:19], s42 offen sc1
  buffer_load_dword v133, v6, s[16:19], s43 offen sc1
  s_waitcnt vmcnt(0)
  v_xor_b32 v130, s94, v130
  v_xor_b32 v131, s94, v131
  v_xor_b32 v132, s94, v132
  v_xor_b32 v133, s94, v133
  v_or_b32 v130, v130, v131
  v_or_b32 v130, v130, v132
  v_or_b32 v130, v130, v133
  v_cmp_ne_u32 vcc, 0, v130
  s_add_u32 s37, s37, 1
  s_cmp_eq_u64 vcc, 0
  s_cbranch_scc1 P1_UCPOLL_OK
  s_cmp_lt_u32 s37, 0x8000
  s_cbranch_scc0 P1_UCPOLL_OK
  s_sleep 2
  s_branch P1_UCPOLL
P1_UCPOLL_OK:
P1_UC_NOPOLL:
P1_UCL:
  s_barrier
  v_add_u32 v104, s34, v2
  v_add_u32 v105, s34, v3
  v_add_u32 v106, s34, v4
  ds_read_b64_tr_b16 v[48:49], v104 offset:0
  ds_read_b64_tr_b16 v[50:51], v104 offset:2048
  v_mfma_f32_16x16x32_bf16 v[8:11], v[76:79], v[84:87], v[8:11]
  ds_read_b64_tr_b16 v[52:53], v105 offset:0
  ds_read_b64_tr_b16 v[54:55], v105 offset:2048
  v_mfma_f32_16x16x32_bf16 v[28:31], v[80:83], v[84:87], v[28:31]
  ds_read_b64_tr_b16 v[56:57], v106 offset:0
  ds_read_b64_tr_b16 v[58:59], v106 offset:2560
  v_mfma_f32_16x16x32_bf16 v[12:15], v[76:79], v[88:91], v[12:15]
  ds_read_b64_tr_b16 v[60:61], v106 offset:32
  ds_read_b64_tr_b16 v[62:63], v106 offset:2592
  v_mfma_f32_16x16x32_bf16 v[32:35], v[80:83], v[88:91], v[32:35]
  ds_read_b64_tr_b16 v[64:65], v106 offset:64
  v_mfma_f32_16x16x32_bf16 v[16:19], v[76:79], v[92:95], v[16:19]
  ds_read_b64_tr_b16 v[66:67], v106 offset:2624
  v_mfma_f32_16x16x32_bf16 v[36:39], v[80:83], v[92:95], v[36:39]
  ds_read_b64_tr_b16 v[68:69], v106 offset:96
  v_mfma_f32_16x16x32_bf16 v[20:23], v[76:79], v[96:99], v[20:23]
  ds_read_b64_tr_b16 v[70:71], v106 offset:2656
  v_mfma_f32_16x16x32_bf16 v[40:43], v[80:83], v[96:99], v[40:43]
  ds_read_b64_tr_b16 v[72:73], v106 offset:128
  v_mfma_f32_16x16x32_bf16 v[24:27], v[76:79], v[100:103], v[24:27]
  ds_read_b64_tr_b16 v[74:75], v106 offset:2688
  v_mfma_f32_16x16x32_bf16 v[44:47], v[80:83], v[100:103], v[44:47]
  s_add_u32 s34, s34, 26624
  s_cmp_eq_u32 s34, 106496
  s_cselect_b32 s34, 0, s34
  ds_read_b64_tr_b16 v[76:77], v104 offset:4096
  ds_read_b64_tr_b16 v[78:79], v104 offset:6144
  s_waitcnt lgkmcnt(10)
  v_mfma_f32_16x16x32_bf16 v[8:11], v[48:51], v[56:59], v[8:11]
  ds_read_b64_tr_b16 v[80:81], v105 offset:4096
  ds_read_b64_tr_b16 v[82:83], v105 offset:6144
  v_mfma_f32_16x16x32_bf16 v[28:31], v[52:55], v[56:59], v[28:31]
  ds_read_b64_tr_b16 v[84:85], v106 offset:5120
  ds_read_b64_tr_b16 v[86:87], v106 offset:7680
  s_waitcnt lgkmcnt(12)
  v_mfma_f32_16x16x32_bf16 v[12:15], v[48:51], v[60:63], v[12:15]
  ds_read_b64_tr_b16 v[88:89], v106 offset:5152
  ds_read_b64_tr_b16 v[90:91], v106 offset:7712
  v_mfma_f32_16x16x32_bf16 v[32:35], v[52:55], v[60:63], v[32:35]
  ds_read_b64_tr_b16 v[92:93], v106 offset:5184
  s_waitcnt lgkmcnt(13)
  v_mfma_f32_16x16x32_bf16 v[16:19], v[48:51], v[64:67], v[16:19]
  ds_read_b64_tr_b16 v[94:95], v106 offset:7744
  v_mfma_f32_16x16x32_bf16 v[36:39], v[52:55], v[64:67], v[36:39]
  ds_read_b64_tr_b16 v[96:97], v106 offset:5216
  s_waitcnt lgkmcnt(13)
  v_mfma_f32_16x16x32_bf16 v[20:23], v[48:51], v[68:71], v[20:23]
  ds_read_b64_tr_b16 v[98:99], v106 offset:7776
  v_mfma_f32_16x16x32_bf16 v[40:43], v[52:55], v[68:71], v[40:43]
  ds_read_b64_tr_b16 v[100:101], v106 offset:5248
  s_waitcnt lgkmcnt(13)
  v_mfma_f32_16x16x32_bf16 v[24:27], v[48:51], v[72:75], v[24:27]
  ds_read_b64_tr_b16 v[102:103], v106 offset:7808
  v_mfma_f32_16x16x32_bf16 v[44:47], v[52:55], v[72:75], v[44:47]
  s_waitcnt lgkmcnt(0)
  s_sub_u32 s35, s35, 1
  s_cmp_lg_u32 s35, 0
  s_cbranch_scc1 P1_UCL
  s_barrier
  v_mfma_f32_16x16x32_bf16 v[8:11], v[76:79], v[84:87], v[8:11]
  v_mfma_f32_16x16x32_bf16 v[28:31], v[80:83], v[84:87], v[28:31]
  v_mfma_f32_16x16x32_bf16 v[12:15], v[76:79], v[88:91], v[12:15]
  v_mfma_f32_16x16x32_bf16 v[32:35], v[80:83], v[88:91], v[32:35]
  v_mfma_f32_16x16x32_bf16 v[16:19], v[76:79], v[92:95], v[16:19]
  v_mfma_f32_16x16x32_bf16 v[36:39], v[80:83], v[92:95], v[36:39]
  v_mfma_f32_16x16x32_bf16 v[20:23], v[76:79], v[96:99], v[20:23]
  v_mfma_f32_16x16x32_bf16 v[40:43], v[80:83], v[96:99], v[40:43]
  v_mfma_f32_16x16x32_bf16 v[24:27], v[76:79], v[100:103], v[24:27]
  v_mfma_f32_16x16x32_bf16 v[44:47], v[80:83], v[100:103], v[44:47]
  s_lshl_b32 s30, s26, 2
  s_add_u32 s30, s30, s24
  s_cmp_ge_u32 s30, 54
  s_cbranch_scc1 P1_USKIP
  s_mul_i32 s31, s25, 54
  s_add_u32 s30, s30, s31
  s_mul_i32 s30, s30, 5120
  s_add_u32 s30, s30, 6160384
  v_lshlrev_b32 v5, 4, v1
  s_waitcnt vmcnt(0)
  v_lshlrev_b32 v108, 16, v116
  v_and_b32 v109, 0xffff0000, v116
  v_lshlrev_b32 v110, 16, v117
  v_and_b32 v111, 0xffff0000, v117
  v_lshlrev_b32 v112, 16, v118
  v_and_b32 v113, 0xffff0000, v118
  v_lshlrev_b32 v114, 16, v119
  v_and_b32 v115, 0xffff0000, v119
  v_mov_b32 v120, 0xc0135761
  v_mov_b32 v122, 0xbdd2d3e8
  v_mov_b32 v124, 1.0
  v_pk_add_f32 v[8:9], v[8:9], v[108:109]
  v_pk_add_f32 v[10:11], v[10:11], v[110:111]
  v_pk_add_f32 v[28:29], v[28:29], v[112:113]
  v_pk_add_f32 v[30:31], v[30:31], v[114:115]
  v_pk_mul_f32 v[48:49], v[8:9], v[8:9]
  v_pk_mul_f32 v[50:51], v[10:11], v[10:11]
  v_pk_mul_f32 v[52:53], v[28:29], v[28:29]
  v_pk_mul_f32 v[54:55], v[30:31], v[30:31]
  v_pk_fma_f32 v[48:49], v[48:49], v[122:123], v[120:121] op_sel_hi:[1,0,0]
  v_pk_fma_f32 v[50:51], v[50:51], v[122:123], v[120:121] op_sel_hi:[1,0,0]
  v_pk_fma_f32 v[52:53], v[52:53], v[122:123], v[120:121] op_sel_hi:[1,0,0]
  v_pk_fma_f32 v[54:55], v[54:55], v[122:123], v[120:121] op_sel_hi:[1,0,0]
  v_pk_mul_f32 v[48:49], v[48:49], v[8:9]
  v_pk_mul_f32 v[50:51], v[50:51], v[10:11]
  v_pk_mul_f32 v[52:53], v[52:53], v[28:29]
  v_pk_mul_f32 v[54:55], v[54:55], v[30:31]
  v_exp_f32 v48, v48
  v_exp_f32 v50, v50
  v_exp_f32 v52, v52
  v_exp_f32 v54, v54
  v_exp_f32 v49, v49
  v_exp_f32 v51, v51
  v_exp_f32 v53, v53
  v_exp_f32 v55, v55
  v_pk_add_f32 v[48:49], v[48:49], v[124:125] op_sel_hi:[1,0]
  v_pk_add_f32 v[50:51], v[50:51], v[124:125] op_sel_hi:[1,0]
  v_pk_add_f32 v[52:53], v[52:53], v[124:125] op_sel_hi:[1,0]
  v_pk_add_f32 v[54:55], v[54:55], v[124:125] op_sel_hi:[1,0]
  v_rcp_f32 v48, v48
  v_rcp_f32 v50, v50
  v_rcp_f32 v52, v52
  v_rcp_f32 v54, v54
  v_rcp_f32 v49, v49
  v_rcp_f32 v51, v51
  v_rcp_f32 v53, v53
  v_rcp_f32 v55, v55
  v_pk_mul_f32 v[8:9], v[8:9], v[48:49]
  v_pk_mul_f32 v[10:11], v[10:11], v[50:51]
  v_pk_mul_f32 v[28:29], v[28:29], v[52:53]
  v_pk_mul_f32 v[30:31], v[30:31], v[54:55]
  v_cvt_pk_bf16_f32 v64, v8, v9
  v_cvt_pk_bf16_f32 v65, v10, v11
  v_cvt_pk_bf16_f32 v66, v28, v29
  v_cvt_pk_bf16_f32 v67, v30, v31
  buffer_store_dwordx4 v[64:67], v5, s[16:19], s30 offen offset:0 sc1
  v_pk_add_f32 v[12:13], v[12:13], v[108:109]
  v_pk_add_f32 v[14:15], v[14:15], v[110:111]
  v_pk_add_f32 v[32:33], v[32:33], v[112:113]
  v_pk_add_f32 v[34:35], v[34:35], v[114:115]
  v_pk_mul_f32 v[56:57], v[12:13], v[12:13]
  v_pk_mul_f32 v[58:59], v[14:15], v[14:15]
  v_pk_mul_f32 v[60:61], v[32:33], v[32:33]
  v_pk_mul_f32 v[62:63], v[34:35], v[34:35]
  v_pk_fma_f32 v[56:57], v[56:57], v[122:123], v[120:121] op_sel_hi:[1,0,0]
  v_pk_fma_f32 v[58:59], v[58:59], v[122:123], v[120:121] op_sel_hi:[1,0,0]
  v_pk_fma_f32 v[60:61], v[60:61], v[122:123], v[120:121] op_sel_hi:[1,0,0]
  v_pk_fma_f32 v[62:63], v[62:63], v[122:123], v[120:121] op_sel_hi:[1,0,0]
  v_pk_mul_f32 v[56:57], v[56:57], v[12:13]
  v_pk_mul_f32 v[58:59], v[58:59], v[14:15]
  v_pk_mul_f32 v[60:61], v[60:61], v[32:33]
  v_pk_mul_f32 v[62:63], v[62:63], v[34:35]
  v_exp_f32 v56, v56
  v_exp_f32 v58, v58
  v_exp_f32 v60, v60
  v_exp_f32 v62, v62
  v_exp_f32 v57, v57
  v_exp_f32 v59, v59
  v_exp_f32 v61, v61
  v_exp_f32 v63, v63
  v_pk_add_f32 v[56:57], v[56:57], v[124:125] op_sel_hi:[1,0]
  v_pk_add_f32 v[58:59], v[58:59], v[124:125] op_sel_hi:[1,0]
  v_pk_add_f32 v[60:61], v[60:61], v[124:125] op_sel_hi:[1,0]
  v_pk_add_f32 v[62:63], v[62:63], v[124:125] op_sel_hi:[1,0]
  v_rcp_f32 v56, v56
  v_rcp_f32 v58, v58
  v_rcp_f32 v60, v60
  v_rcp_f32 v62, v62
  v_rcp_f32 v57, v57
  v_rcp_f32 v59, v59
  v_rcp_f32 v61, v61
  v_rcp_f32 v63, v63
  v_pk_mul_f32 v[12:13], v[12:13], v[56:57]
  v_pk_mul_f32 v[14:15], v[14:15], v[58:59]
  v_pk_mul_f32 v[32:33], v[32:33], v[60:61]
  v_pk_mul_f32 v[34:35], v[34:35], v[62:63]
  v_cvt_pk_bf16_f32 v68, v12, v13
  v_cvt_pk_bf16_f32 v69, v14, v15
  v_cvt_pk_bf16_f32 v70, v32, v33
  v_cvt_pk_bf16_f32 v71, v34, v35
  buffer_store_dwordx4 v[68:71], v5, s[16:19], s30 offen offset:1024 sc1
  v_pk_add_f32 v[16:17], v[16:17], v[108:109]
  v_pk_add_f32 v[18:19], v[18:19], v[110:111]
  v_pk_add_f32 v[36:37], v[36:37], v[112:113]
  v_pk_add_f32 v[38:39], v[38:39], v[114:115]
  v_pk_mul_f32 v[48:49], v[16:17], v[16:17]
  v_pk_mul_f32 v[50:51], v[18:19], v[18:19]
  v_pk_mul_f32 v[52:53], v[36:37], v[36:37]
  v_pk_mul_f32 v[54:55], v[38:39], v[38:39]
  v_pk_fma_f32 v[48:49], v[48:49], v[122:123], v[120:121] op_sel_hi:[1,0,0]
  v_pk_fma_f32 v[50:51], v[50:51], v[122:123], v[120:121] op_sel_hi:[1,0,0]
  v_pk_fma_f32 v[52:53], v[52:53], v[122:123], v[120:121] op_sel_hi:[1,0,0]
  v_pk_fma_f32 v[54:55], v[54:55], v[122:123], v[120:121] op_sel_hi:[1,0,0]
  v_pk_mul_f32 v[48:49], v[48:49], v[16:17]
  v_pk_mul_f32 v[50:51], v[50:51], v[18:19]
  v_pk_mul_f32 v[52:53], v[52:53], v[36:37]
  v_pk_mul_f32 v[54:55], v[54:55], v[38:39]
  v_exp_f32 v48, v48
  v_exp_f32 v50, v50
  v_exp_f32 v52, v52
  v_exp_f32 v54, v54
  v_exp_f32 v49, v49
  v_exp_f32 v51, v51
  v_exp_f32 v53, v53
  v_exp_f32 v55, v55
  v_pk_add_f32 v[48:49], v[48:49], v[124:125] op_sel_hi:[1,0]
  v_pk_add_f32 v[50:51], v[50:51], v[124:125] op_sel_hi:[1,0]
  v_pk_add_f32 v[52:53], v[52:53], v[124:125] op_sel_hi:[1,0]
  v_pk_add_f32 v[54:55], v[54:55], v[124:125] op_sel_hi:[1,0]
  v_rcp_f32 v48, v48
  v_rcp_f32 v50, v50
  v_rcp_f32 v52, v52
  v_rcp_f32 v54, v54
  v_rcp_f32 v49, v49
  v_rcp_f32 v51, v51
  v_rcp_f32 v53, v53
  v_rcp_f32 v55, v55
  v_pk_mul_f32 v[16:17], v[16:17], v[48:49]
  v_pk_mul_f32 v[18:19], v[18:19], v[50:51]
  v_pk_mul_f32 v[36:37], v[36:37], v[52:53]
  v_pk_mul_f32 v[38:39], v[38:39], v[54:55]
  v_cvt_pk_bf16_f32 v72, v16, v17
  v_cvt_pk_bf16_f32 v73, v18, v19
  v_cvt_pk_bf16_f32 v74, v36, v37
  v_cvt_pk_bf16_f32 v75, v38, v39
  buffer_store_dwordx4 v[72:75], v5, s[16:19], s30 offen offset:2048 sc1
  v_pk_add_f32 v[20:21], v[20:21], v[108:109]
  v_pk_add_f32 v[22:23], v[22:23], v[110:111]
  v_pk_add_f32 v[40:41], v[40:41], v[112:113]
  v_pk_add_f32 v[42:43], v[42:43], v[114:115]
  v_pk_mul_f32 v[56:57], v[20:21], v[20:21]
  v_pk_mul_f32 v[58:59], v[22:23], v[22:23]
  v_pk_mul_f32 v[60:61], v[40:41], v[40:41]
  v_pk_mul_f32 v[62:63], v[42:43], v[42:43]
  v_pk_fma_f32 v[56:57], v[56:57], v[122:123], v[120:121] op_sel_hi:[1,0,0]
  v_pk_fma_f32 v[58:59], v[58:59], v[122:123], v[120:121] op_sel_hi:[1,0,0]
  v_pk_fma_f32 v[60:61], v[60:61], v[122:123], v[120:121] op_sel_hi:[1,0,0]
  v_pk_fma_f32 v[62:63], v[62:63], v[122:123], v[120:121] op_sel_hi:[1,0,0]
  v_pk_mul_f32 v[56:57], v[56:57], v[20:21]
  v_pk_mul_f32 v[58:59], v[58:59], v[22:23]
  v_pk_mul_f32 v[60:61], v[60:61], v[40:41]
  v_pk_mul_f32 v[62:63], v[62:63], v[42:43]
  v_exp_f32 v56, v56
  v_exp_f32 v58, v58
  v_exp_f32 v60, v60
  v_exp_f32 v62, v62
  v_exp_f32 v57, v57
  v_exp_f32 v59, v59
  v_exp_f32 v61, v61
  v_exp_f32 v63, v63
  v_pk_add_f32 v[56:57], v[56:57], v[124:125] op_sel_hi:[1,0]
  v_pk_add_f32 v[58:59], v[58:59], v[124:125] op_sel_hi:[1,0]
  v_pk_add_f32 v[60:61], v[60:61], v[124:125] op_sel_hi:[1,0]
  v_pk_add_f32 v[62:63], v[62:63], v[124:125] op_sel_hi:[1,0]
  v_rcp_f32 v56, v56
  v_rcp_f32 v58, v58
  v_rcp_f32 v60, v60
  v_rcp_f32 v62, v62
  v_rcp_f32 v57, v57
  v_rcp_f32 v59, v59
  v_rcp_f32 v61, v61
  v_rcp_f32 v63, v63
  v_pk_mul_f32 v[20:21], v[20:21], v[56:57]
  v_pk_mul_f32 v[22:23], v[22:23], v[58:59]
  v_pk_mul_f32 v[40:41], v[40:41], v[60:61]
  v_pk_mul_f32 v[42:43], v[42:43], v[62:63]
  v_cvt_pk_bf16_f32 v64, v20, v21
  v_cvt_pk_bf16_f32 v65, v22, v23
  v_cvt_pk_bf16_f32 v66, v40, v41
  v_cvt_pk_bf16_f32 v67, v42, v43
  buffer_store_dwordx4 v[64:67], v5, s[16:19], s30 offen offset:3072 sc1
  v_pk_add_f32 v[24:25], v[24:25], v[108:109]
  v_pk_add_f32 v[26:27], v[26:27], v[110:111]
  v_pk_add_f32 v[44:45], v[44:45], v[112:113]
  v_pk_add_f32 v[46:47], v[46:47], v[114:115]
  v_pk_mul_f32 v[48:49], v[24:25], v[24:25]
  v_pk_mul_f32 v[50:51], v[26:27], v[26:27]
  v_pk_mul_f32 v[52:53], v[44:45], v[44:45]
  v_pk_mul_f32 v[54:55], v[46:47], v[46:47]
  v_pk_fma_f32 v[48:49], v[48:49], v[122:123], v[120:121] op_sel_hi:[1,0,0]
  v_pk_fma_f32 v[50:51], v[50:51], v[122:123], v[120:121] op_sel_hi:[1,0,0]
  v_pk_fma_f32 v[52:53], v[52:53], v[122:123], v[120:121] op_sel_hi:[1,0,0]
  v_pk_fma_f32 v[54:55], v[54:55], v[122:123], v[120:121] op_sel_hi:[1,0,0]
  v_pk_mul_f32 v[48:49], v[48:49], v[24:25]
  v_pk_mul_f32 v[50:51], v[50:51], v[26:27]
  v_pk_mul_f32 v[52:53], v[52:53], v[44:45]
  v_pk_mul_f32 v[54:55], v[54:55], v[46:47]
  v_exp_f32 v48, v48
  v_exp_f32 v50, v50
  v_exp_f32 v52, v52
  v_exp_f32 v54, v54
  v_exp_f32 v49, v49
  v_exp_f32 v51, v51
  v_exp_f32 v53, v53
  v_exp_f32 v55, v55
  v_pk_add_f32 v[48:49], v[48:49], v[124:125] op_sel_hi:[1,0]
  v_pk_add_f32 v[50:51], v[50:51], v[124:125] op_sel_hi:[1,0]
  v_pk_add_f32 v[52:53], v[52:53], v[124:125] op_sel_hi:[1,0]
  v_pk_add_f32 v[54:55], v[54:55], v[124:125] op_sel_hi:[1,0]
  v_rcp_f32 v48, v48
  v_rcp_f32 v50, v50
  v_rcp_f32 v52, v52
  v_rcp_f32 v54, v54
  v_rcp_f32 v49, v49
  v_rcp_f32 v51, v51
  v_rcp_f32 v53, v53
  v_rcp_f32 v55, v55
  v_pk_mul_f32 v[24:25], v[24:25], v[48:49]
  v_pk_mul_f32 v[26:27], v[26:27], v[50:51]
  v_pk_mul_f32 v[44:45], v[44:45], v[52:53]
  v_pk_mul_f32 v[46:47], v[46:47], v[54:55]
  v_cvt_pk_bf16_f32 v68, v24, v25
  v_cvt_pk_bf16_f32 v69, v26, v27
  v_cvt_pk_bf16_f32 v70, v44, v45
  v_cvt_pk_bf16_f32 v71, v46, v47
  s_add_u32 s30, s30, 4096
  buffer_store_dwordx4 v[68:71], v5, s[16:19], s30 offen offset:0 sc1
P1_USKIP:
  s_lshl_b32 s30, s25, 8
  s_lshl_b32 s31, s26, 4
  s_add_u32 s30, s30, s31
  s_add_u32 s30, s30, 40960
  s_waitcnt vmcnt(0)
  s_mov_b64 exec, 1
  v_mov_b32 v2, 163780
  v_mov_b32 v3, 1
  ds_add_rtn_u32 v3, v2, v3
  s_waitcnt lgkmcnt(0)
  v_readfirstlane_b32 s31, v3
  s_cmp_lg_u32 s31, 3
  s_cbranch_scc1 P1_USIG
  s_mov_b64 exec, 1
  v_mul_u32_u24 v2, 0, v1
  v_mov_b32 v3, s94
  buffer_store_dword v3, v2, s[16:19], s30 offen sc1
P1_USIG:
  s_mov_b64 exec, -1
  s_branch P3_ENTRY
P1_QL:
  s_mov_b32 s20, s74
  s_and_b32 s21, s75, 0xffff
  s_mov_b32 s22, 2457600
  s_mov_b32 s23, 0x20000
  v_lshlrev_b32 v2, 4, v1
  s_lshl_b32 s30, s25, 3
  s_mul_i32 s31, s30, 20480
  s_sub_u32 s32, s31, 20480
  s_cmp_eq_u32 s25, 0
  s_cselect_b32 s32, s31, s32
  s_add_u32 s31, s31, 65536
  s_add_u32 s32, s32, 65536
  s_mul_i32 s33, s26, 160
  s_cmp_lg_u32 s24, 4
  s_cbranch_scc1 P1_QL0_NEXT
  v_min_u32 v7, 17, v1
  s_lshl_b32 s37, s25, 4
  s_sub_u32 s37, s37, 2
  v_add_u32 v7, s37, v7
  v_max_i32 v7, 0, v7
  v_lshlrev_b32 v6, 4, v7
  s_and_b32 s40, s2, 7
  s_lshl_b32 s40, s40, 12
  s_mov_b32 s37, 0
P1_QPOLL:
  buffer_load_dword v8, v6, s[16:19], s40 offen sc1
  s_waitcnt vmcnt(0)
  v_cmp_ne_u32 vcc, s94, v8
  s_add_u32 s37, s37, 1
  s_cmp_eq_u64 vcc, 0
  s_cbranch_scc1 P1_QPOLL_OK
  s_cmp_lt_u32 s37, 0x8000
  s_cbranch_scc0 P1_QPOLL_OK
  s_sleep 2
  s_branch P1_QPOLL
P1_QPOLL_OK:
  v_mov_b32 v6, 163784
  v_mov_b32 v7, 1
  ds_write_b32 v6, v7
  s_waitcnt lgkmcnt(0)
  s_mov_b32 s34, 0
  s_mov_b32 s36, 2
P1_QL0_S_0:
  s_add_u32 m0, s34, 15360
  s_nop 0
  buffer_load_dwordx4 v2, s[16:19], s32 offen sc1 lds
  s_add_u32 m0, s34, 16384
  s_nop 0
  buffer_load_dwordx4 v2, s[16:19], s31 offen sc1 lds
  s_add_u32 m0, s34, 17408
  s_add_u32 s35, s31, 20480
  buffer_load_dwordx4 v2, s[16:19], s35 offen sc1 lds
  s_add_u32 m0, s34, 18432
  s_add_u32 s35, s31, 40960
  buffer_load_dwordx4 v2, s[16:19], s35 offen sc1 lds
  s_add_u32 m0, s34, 19456
  s_add_u32 s35, s31, 61440
  buffer_load_dwordx4 v2, s[16:19], s35 offen sc1 lds
  s_add_u32 m0, s34, 20480
  s_add_u32 s35, s31, 81920
  buffer_load_dwordx4 v2, s[16:19], s35 offen sc1 lds
  s_add_u32 s31, s31, 1024
  s_add_u32 s32, s32, 1024
  s_add_u32 s33, s33, 122880
  s_add_u32 s34, s34, 24576
  s_cmp_eq_u32 s34, 73728
  s_cselect_b32 s34, 0, s34
  s_sub_u32 s36, s36, 1
  s_cmp_lg_u32 s36, 0
  s_cbranch_scc1 P1_QL0_S_0
  s_mov_b32 s36, 18
P1_QL0_S_1:
  s_waitcnt vmcnt(6)
  s_barrier
  s_add_u32 m0, s34, 15360
  s_nop 0
  buffer_load_dwordx4 v2, s[16:19], s32 offen sc1 lds
  s_add_u32 m0, s34, 16384
  s_nop 0
  buffer_load_dwordx4 v2, s[16:19], s31 offen sc1 lds
  s_add_u32 m0, s34, 17408
  s_add_u32 s35, s31, 20480
  buffer_load_dwordx4 v2, s[16:19], s35 offen sc1 lds
  s_add_u32 m0, s34, 18432
  s_add_u32 s35, s31, 40960
  buffer_load_dwordx4 v2, s[16:19], s35 offen sc1 lds
  s_add_u32 m0, s34, 19456
  s_add_u32 s35, s31, 61440
  buffer_load_dwordx4 v2, s[16:19], s35 offen sc1 lds
  s_add_u32 m0, s34, 20480
  s_add_u32 s35, s31, 81920
  buffer_load_dwordx4 v2, s[16:19], s35 offen sc1 lds
  s_add_u32 s31, s31, 1024
  s_add_u32 s32, s32, 1024
  s_add_u32 s33, s33, 122880
  s_add_u32 s34, s34, 24576
  s_cmp_eq_u32 s34, 73728
  s_cselect_b32 s34, 0, s34
  s_sub_u32 s36, s36, 1
  s_cmp_lg_u32 s36, 0
  s_cbranch_scc1 P1_QL0_S_1
  s_waitcnt vmcnt(6)
  s_barrier
  s_waitcnt vmcnt(0)
  s_barrier
  s_mov_b32 s44, s84
  s_and_b32 s45, s85, 0xffff
  s_mov_b32 s46, 7077888
  s_mov_b32 s47, 0x20000
  s_lshr_b32 s38, s2, 3
  s_cmp_ge_u32 s38, 27
  s_cbranch_scc1 P1_NOPF1772
  s_cmp_lg_u32 s24, 4
  s_cbranch_scc1 P1_NOPF1772
  s_mul_i32 s38, s38, 262144
  s_lshr_b32 s39, s84, 7
  s_sub_u32 s39, 3, s39
  s_and_b32 s39, s39, 7
  s_lshl_b32 s39, s39, 7
  s_add_u32 s38, s38, s39
  s_and_b32 s39, s2, 7
  s_lshr_b32 s39, s39, 1
  s_lshl_b32 s39, s39, 10
  s_add_u32 s38, s38, s39
  v_lshlrev_b32 v252, 12, v1
  buffer_load_dword v253, v252, s[44:47], s38 offen
P1_NOPF1772:
  s_barrier
  s_branch P3_ENTRY
P1_QL0_NEXT:
  s_cmp_lg_u32 s24, 5
  s_cbranch_scc1 P1_QL1_NEXT
  v_add_u32 v4, 0, v1
  v_mul_u32_u24 v5, 2185, v4
  v_lshrrev_b32 v5, 16, v5
  v_mul_u32_u24 v6, 30, v5
  v_sub_u32 v6, v4, v6
  v_mul_u32_u24 v7, 6554, v6
  v_lshrrev_b32 v7, 16, v7
  v_mul_u32_u24 v8, 10, v7
  v_sub_u32 v6, v6, v8
  v_mul_u32_u24 v7, 1280, v7
  v_lshl_add_u32 v6, v6, 4, v7
  v_bfe_u32 v7, v5, 2, 2
  v_lshlrev_b32 v7, 3, v7
  v_lshrrev_b32 v8, 4, v5
  v_lshl_add_u32 v7, v8, 2, v7
  v_and_b32 v8, 3, v5
  v_add_u32 v7, v7, v8
  v_mul_u32_u24 v7, 3840, v7
  v_add_u32 v10, v6, v7
  v_add_u32 v4, 64, v1
  v_mul_u32_u24 v5, 2185, v4
  v_lshrrev_b32 v5, 16, v5
  v_mul_u32_u24 v6, 30, v5
  v_sub_u32 v6, v4, v6
  v_mul_u32_u24 v7, 6554, v6
  v_lshrrev_b32 v7, 16, v7
  v_mul_u32_u24 v8, 10, v7
  v_sub_u32 v6, v6, v8
  v_mul_u32_u24 v7, 1280, v7
  v_lshl_add_u32 v6, v6, 4, v7
  v_bfe_u32 v7, v5, 2, 2
  v_lshlrev_b32 v7, 3, v7
  v_lshrrev_b32 v8, 4, v5
  v_lshl_add_u32 v7, v8, 2, v7
  v_and_b32 v8, 3, v5
  v_add_u32 v7, v7, v8
  v_mul_u32_u24 v7, 3840, v7
  v_add_u32 v11, v6, v7
  v_add_u32 v4, 128, v1
  v_mul_u32_u24 v5, 2185, v4
  v_lshrrev_b32 v5, 16, v5
  v_mul_u32_u24 v6, 30, v5
  v_sub_u32 v6, v4, v6
  v_mul_u32_u24 v7, 6554, v6
  v_lshrrev_b32 v7, 16, v7
  v_mul_u32_u24 v8, 10, v7
  v_sub_u32 v6, v6, v8
  v_mul_u32_u24 v7, 1280, v7
  v_lshl_add_u32 v6, v6, 4, v7
  v_bfe_u32 v7, v5, 2, 2
  v_lshlrev_b32 v7, 3, v7
  v_lshrrev_b32 v8, 4, v5
  v_lshl_add_u32 v7, v8, 2, v7
  v_and_b32 v8, 3, v5
  v_add_u32 v7, v7, v8
  v_mul_u32_u24 v7, 3840, v7
  v_add_u32 v12, v6, v7
  v_mov_b32 v6, 163784
  s_mov_b32 s37, 0
P1_QW1:
  ds_read_b32 v7, v6
  s_waitcnt lgkmcnt(0)
  v_readfirstlane_b32 s38, v7
  s_add_u32 s37, s37, 1
  s_cmp_ge_u32 s38, 1
  s_cbranch_scc1 P1_QW1_OK
  s_cmp_lt_u32 s37, 0x400000
  s_cbranch_scc0 P1_QW1_OK
  s_sleep 1
  s_branch P1_QW1
P1_QW1_OK:
  s_mov_b32 s34, 0
  s_mov_b32 s36, 2
P1_QL1_S_0:
  s_add_u32 m0, s34, 21504
  s_add_u32 s35, s31, 102400
  buffer_load_dwordx4 v2, s[16:19], s35 offen sc1 lds
  s_add_u32 m0, s34, 22528
  s_add_u32 s35, s31, 122880
  buffer_load_dwordx4 v2, s[16:19], s35 offen sc1 lds
  s_add_u32 m0, s34, 23552
  s_add_u32 s35, s31, 143360
  buffer_load_dwordx4 v2, s[16:19], s35 offen sc1 lds
  s_add_u32 m0, s34, 0
  s_nop 0
  buffer_load_dwordx4 v10, s[20:23], s33 offen  lds
  s_add_u32 m0, s34, 1024
  s_nop 0
  buffer_load_dwordx4 v11, s[20:23], s33 offen  lds
  s_add_u32 m0, s34, 2048
  s_nop 0
  buffer_load_dwordx4 v12, s[20:23], s33 offen  lds
  s_add_u32 s31, s31, 1024
  s_add_u32 s32, s32, 1024
  s_add_u32 s33, s33, 122880
  s_add_u32 s34, s34, 24576
  s_cmp_eq_u32 s34, 73728
  s_cselect_b32 s34, 0, s34
  s_sub_u32 s36, s36, 1
  s_cmp_lg_u32 s36, 0
  s_cbranch_scc1 P1_QL1_S_0
  s_mov_b32 s36, 18
P1_QL1_S_1:
  s_waitcnt vmcnt(6)
  s_barrier
  s_add_u32 m0, s34, 21504
  s_add_u32 s35, s31, 102400
  buffer_load_dwordx4 v2, s[16:19], s35 offen sc1 lds
  s_add_u32 m0, s34, 22528
  s_add_u32 s35, s31, 122880
  buffer_load_dwordx4 v2, s[16:19], s35 offen sc1 lds
  s_add_u32 m0, s34, 23552
  s_add_u32 s35, s31, 143360
  buffer_load_dwordx4 v2, s[16:19], s35 offen sc1 lds
  s_add_u32 m0, s34, 0
  s_nop 0
  buffer_load_dwordx4 v10, s[20:23], s33 offen  lds
  s_add_u32 m0, s34, 1024
  s_nop 0
  buffer_load_dwordx4 v11, s[20:23], s33 offen  lds
  s_add_u32 m0, s34, 2048
  s_nop 0
  buffer_load_dwordx4 v12, s[20:23], s33 offen  lds
  s_add_u32 s31, s31, 1024
  s_add_u32 s32, s32, 1024
  s_add_u32 s33, s33, 122880
  s_add_u32 s34, s34, 24576
  s_cmp_eq_u32 s34, 73728
  s_cselect_b32 s34, 0, s34
  s_sub_u32 s36, s36, 1
  s_cmp_lg_u32 s36, 0
  s_cbranch_scc1 P1_QL1_S_1
  s_waitcnt vmcnt(6)
  s_barrier
  s_waitcnt vmcnt(0)
  s_barrier
  s_mov_b32 s44, s84
  s_and_b32 s45, s85, 0xffff
  s_mov_b32 s46, 7077888
  s_mov_b32 s47, 0x20000
  s_lshr_b32 s38, s2, 3
  s_cmp_ge_u32 s38, 27
  s_cbranch_scc1 P1_NOPF1935
  s_cmp_lg_u32 s24, 4
  s_cbranch_scc1 P1_NOPF1935
  s_mul_i32 s38, s38, 262144
  s_lshr_b32 s39, s84, 7
  s_sub_u32 s39, 3, s39
  s_and_b32 s39, s39, 7
  s_lshl_b32 s39, s39, 7
  s_add_u32 s38, s38, s39
  s_and_b32 s39, s2, 7
  s_lshr_b32 s39, s39, 1
  s_lshl_b32 s39, s39, 10
  s_add_u32 s38, s38, s39
  v_lshlrev_b32 v252, 12, v1
  buffer_load_dword v253, v252, s[44:47], s38 offen
P1_NOPF1935:
  s_barrier
  s_branch P3_ENTRY
P1_QL1_NEXT:
  s_cmp_lg_u32 s24, 6
  s_cbranch_scc1 P1_QL2_NEXT
  v_add_u32 v4, 192, v1
  v_mul_u32_u24 v5, 2185, v4
  v_lshrrev_b32 v5, 16, v5
  v_mul_u32_u24 v6, 30, v5
  v_sub_u32 v6, v4, v6
  v_mul_u32_u24 v7, 6554, v6
  v_lshrrev_b32 v7, 16, v7
  v_mul_u32_u24 v8, 10, v7
  v_sub_u32 v6, v6, v8
  v_mul_u32_u24 v7, 1280, v7
  v_lshl_add_u32 v6, v6, 4, v7
  v_bfe_u32 v7, v5, 2, 2
  v_lshlrev_b32 v7, 3, v7
  v_lshrrev_b32 v8, 4, v5
  v_lshl_add_u32 v7, v8, 2, v7
  v_and_b32 v8, 3, v5
  v_add_u32 v7, v7, v8
  v_mul_u32_u24 v7, 3840, v7
  v_add_u32 v13, v6, v7
  v_add_u32 v4, 256, v1
  v_mul_u32_u24 v5, 2185, v4
  v_lshrrev_b32 v5, 16, v5
  v_mul_u32_u24 v6, 30, v5
  v_sub_u32 v6, v4, v6
  v_mul_u32_u24 v7, 6554, v6
  v_lshrrev_b32 v7, 16, v7
  v_mul_u32_u24 v8, 10, v7
  v_sub_u32 v6, v6, v8
  v_mul_u32_u24 v7, 1280, v7
  v_lshl_add_u32 v6, v6, 4, v7
  v_bfe_u32 v7, v5, 2, 2
  v_lshlrev_b32 v7, 3, v7
  v_lshrrev_b32 v8, 4, v5
  v_lshl_add_u32 v7, v8, 2, v7
  v_and_b32 v8, 3, v5
  v_add_u32 v7, v7, v8
  v_mul_u32_u24 v7, 3840, v7
  v_add_u32 v14, v6, v7
  v_add_u32 v4, 320, v1
  v_mul_u32_u24 v5, 2185, v4
  v_lshrrev_b32 v5, 16, v5
  v_mul_u32_u24 v6, 30, v5
  v_sub_u32 v6, v4, v6
  v_mul_u32_u24 v7, 6554, v6
  v_lshrrev_b32 v7, 16, v7
  v_mul_u32_u24 v8, 10, v7
  v_sub_u32 v6, v6, v8
  v_mul_u32_u24 v7, 1280, v7
  v_lshl_add_u32 v6, v6, 4, v7
  v_bfe_u32 v7, v5, 2, 2
  v_lshlrev_b32 v7, 3, v7
  v_lshrrev_b32 v8, 4, v5
  v_lshl_add_u32 v7, v8, 2, v7
  v_and_b32 v8, 3, v5
  v_add_u32 v7, v7, v8
  v_mul_u32_u24 v7, 3840, v7
  v_add_u32 v15, v6, v7
  v_add_u32 v4, 384, v1
  v_mul_u32_u24 v5, 2185, v4
  v_lshrrev_b32 v5, 16, v5
  v_mul_u32_u24 v6, 30, v5
  v_sub_u32 v6, v4, v6
  v_mul_u32_u24 v7, 6554, v6
  v_lshrrev_b32 v7, 16, v7
  v_mul_u32_u24 v8, 10, v7
  v_sub_u32 v6, v6, v8
  v_mul_u32_u24 v7, 1280, v7
  v_lshl_add_u32 v6, v6, 4, v7
  v_bfe_u32 v7, v5, 2, 2
  v_lshlrev_b32 v7, 3, v7
  v_lshrrev_b32 v8, 4, v5
  v_lshl_add_u32 v7, v8, 2, v7
  v_and_b32 v8, 3, v5
  v_add_u32 v7, v7, v8
  v_mul_u32_u24 v7, 3840, v7
  v_add_u32 v16, v6, v7
  v_add_u32 v4, 448, v1
  v_mul_u32_u24 v5, 2185, v4
  v_lshrrev_b32 v5, 16, v5
  v_mul_u32_u24 v6, 30, v5
  v_sub_u32 v6, v4, v6
  v_mul_u32_u24 v7, 6554, v6
  v_lshrrev_b32 v7, 16, v7
  v_mul_u32_u24 v8, 10, v7
  v_sub_u32 v6, v6, v8
  v_mul_u32_u24 v7, 1280, v7
  v_lshl_add_u32 v6, v6, 4, v7
  v_bfe_u32 v7, v5, 2, 2
  v_lshlrev_b32 v7, 3, v7
  v_lshrrev_b32 v8, 4, v5
  v_lshl_add_u32 v7, v8, 2, v7
  v_and_b32 v8, 3, v5
  v_add_u32 v7, v7, v8
  v_mul_u32_u24 v7, 3840, v7
  v_add_u32 v17, v6, v7
  v_add_u32 v4, 512, v1
  v_mul_u32_u24 v5, 2185, v4
  v_lshrrev_b32 v5, 16, v5
  v_mul_u32_u24 v6, 30, v5
  v_sub_u32 v6, v4, v6
  v_mul_u32_u24 v7, 6554, v6
  v_lshrrev_b32 v7, 16, v7
  v_mul_u32_u24 v8, 10, v7
  v_sub_u32 v6, v6, v8
  v_mul_u32_u24 v7, 1280, v7
  v_lshl_add_u32 v6, v6, 4, v7
  v_bfe_u32 v7, v5, 2, 2
  v_lshlrev_b32 v7, 3, v7
  v_lshrrev_b32 v8, 4, v5
  v_lshl_add_u32 v7, v8, 2, v7
  v_and_b32 v8, 3, v5
  v_add_u32 v7, v7, v8
  v_mul_u32_u24 v7, 3840, v7
  v_add_u32 v18, v6, v7
  s_mov_b32 s34, 0
  s_mov_b32 s36, 2
P1_QL2_S_0:
  s_add_u32 m0, s34, 3072
  s_nop 0
  buffer_load_dwordx4 v13, s[20:23], s33 offen  lds
  s_add_u32 m0, s34, 4096
  s_nop 0
  buffer_load_dwordx4 v14, s[20:23], s33 offen  lds
  s_add_u32 m0, s34, 5120
  s_nop 0
  buffer_load_dwordx4 v15, s[20:23], s33 offen  lds
  s_add_u32 m0, s34, 6144
  s_nop 0
  buffer_load_dwordx4 v16, s[20:23], s33 offen  lds
  s_add_u32 m0, s34, 7168
  s_nop 0
  buffer_load_dwordx4 v17, s[20:23], s33 offen  lds
  s_add_u32 m0, s34, 8192
  s_nop 0
  buffer_load_dwordx4 v18, s[20:23], s33 offen  lds
  s_add_u32 s31, s31, 1024
  s_add_u32 s32, s32, 1024
  s_add_u32 s33, s33, 122880
  s_add_u32 s34, s34, 24576
  s_cmp_eq_u32 s34, 73728
  s_cselect_b32 s34, 0, s34
  s_sub_u32 s36, s36, 1
  s_cmp_lg_u32 s36, 0
  s_cbranch_scc1 P1_QL2_S_0
  s_mov_b32 s36, 18
P1_QL2_S_1:
  s_waitcnt vmcnt(6)
  s_barrier
  s_add_u32 m0, s34, 3072
  s_nop 0
  buffer_load_dwordx4 v13, s[20:23], s33 offen  lds
  s_add_u32 m0, s34, 4096
  s_nop 0
  buffer_load_dwordx4 v14, s[20:23], s33 offen  lds
  s_add_u32 m0, s34, 5120
  s_nop 0
  buffer_load_dwordx4 v15, s[20:23], s33 offen  lds
  s_add_u32 m0, s34, 6144
  s_nop 0
  buffer_load_dwordx4 v16, s[20:23], s33 offen  lds
  s_add_u32 m0, s34, 7168
  s_nop 0
  buffer_load_dwordx4 v17, s[20:23], s33 offen  lds
  s_add_u32 m0, s34, 8192
  s_nop 0
  buffer_load_dwordx4 v18, s[20:23], s33 offen  lds
  s_add_u32 s31, s31, 1024
  s_add_u32 s32, s32, 1024
  s_add_u32 s33, s33, 122880
  s_add_u32 s34, s34, 24576
  s_cmp_eq_u32 s34, 73728
  s_cselect_b32 s34, 0, s34
  s_sub_u32 s36, s36, 1
  s_cmp_lg_u32 s36, 0
  s_cbranch_scc1 P1_QL2_S_1
  s_waitcnt vmcnt(6)
  s_barrier
  s_waitcnt vmcnt(0)
  s_barrier
  s_mov_b32 s44, s84
  s_and_b32 s45, s85, 0xffff
  s_mov_b32 s46, 7077888
  s_mov_b32 s47, 0x20000
  s_lshr_b32 s38, s2, 3
  s_cmp_ge_u32 s38, 27
  s_cbranch_scc1 P1_NOPF2141
  s_cmp_lg_u32 s24, 4
  s_cbranch_scc1 P1_NOPF2141
  s_mul_i32 s38, s38, 262144
  s_lshr_b32 s39, s84, 7
  s_sub_u32 s39, 3, s39
  s_and_b32 s39, s39, 7
  s_lshl_b32 s39, s39, 7
  s_add_u32 s38, s38, s39
  s_and_b32 s39, s2, 7
  s_lshr_b32 s39, s39, 1
  s_lshl_b32 s39, s39, 10
  s_add_u32 s38, s38, s39
  v_lshlrev_b32 v252, 12, v1
  buffer_load_dword v253, v252, s[44:47], s38 offen
P1_NOPF2141:
  s_barrier
  s_branch P3_ENTRY
P1_QL2_NEXT:
  v_add_u32 v4, 576, v1
  v_mul_u32_u24 v5, 2185, v4
  v_lshrrev_b32 v5, 16, v5
  v_mul_u32_u24 v6, 30, v5
  v_sub_u32 v6, v4, v6
  v_mul_u32_u24 v7, 6554, v6
  v_lshrrev_b32 v7, 16, v7
  v_mul_u32_u24 v8, 10, v7
  v_sub_u32 v6, v6, v8
  v_mul_u32_u24 v7, 1280, v7
  v_lshl_add_u32 v6, v6, 4, v7
  v_bfe_u32 v7, v5, 2, 2
  v_lshlrev_b32 v7, 3, v7
  v_lshrrev_b32 v8, 4, v5
  v_lshl_add_u32 v7, v8, 2, v7
  v_and_b32 v8, 3, v5
  v_add_u32 v7, v7, v8
  v_mul_u32_u24 v7, 3840, v7
  v_add_u32 v19, v6, v7
  v_add_u32 v4, 640, v1
  v_mul_u32_u24 v5, 2185, v4
  v_lshrrev_b32 v5, 16, v5
  v_mul_u32_u24 v6, 30, v5
  v_sub_u32 v6, v4, v6
  v_mul_u32_u24 v7, 6554, v6
  v_lshrrev_b32 v7, 16, v7
  v_mul_u32_u24 v8, 10, v7
  v_sub_u32 v6, v6, v8
  v_mul_u32_u24 v7, 1280, v7
  v_lshl_add_u32 v6, v6, 4, v7
  v_bfe_u32 v7, v5, 2, 2
  v_lshlrev_b32 v7, 3, v7
  v_lshrrev_b32 v8, 4, v5
  v_lshl_add_u32 v7, v8, 2, v7
  v_and_b32 v8, 3, v5
  v_add_u32 v7, v7, v8
  v_mul_u32_u24 v7, 3840, v7
  v_add_u32 v20, v6, v7
  v_add_u32 v4, 704, v1
  v_mul_u32_u24 v5, 2185, v4
  v_lshrrev_b32 v5, 16, v5
  v_mul_u32_u24 v6, 30, v5
  v_sub_u32 v6, v4, v6
  v_mul_u32_u24 v7, 6554, v6
  v_lshrrev_b32 v7, 16, v7
  v_mul_u32_u24 v8, 10, v7
  v_sub_u32 v6, v6, v8
  v_mul_u32_u24 v7, 1280, v7
  v_lshl_add_u32 v6, v6, 4, v7
  v_bfe_u32 v7, v5, 2, 2
  v_lshlrev_b32 v7, 3, v7
  v_lshrrev_b32 v8, 4, v5
  v_lshl_add_u32 v7, v8, 2, v7
  v_and_b32 v8, 3, v5
  v_add_u32 v7, v7, v8
  v_mul_u32_u24 v7, 3840, v7
  v_add_u32 v21, v6, v7
  v_add_u32 v4, 768, v1
  v_mul_u32_u24 v5, 2185, v4
  v_lshrrev_b32 v5, 16, v5
  v_mul_u32_u24 v6, 30, v5
  v_sub_u32 v6, v4, v6
  v_mul_u32_u24 v7, 6554, v6
  v_lshrrev_b32 v7, 16, v7
  v_mul_u32_u24 v8, 10, v7
  v_sub_u32 v6, v6, v8
  v_mul_u32_u24 v7, 1280, v7
  v_lshl_add_u32 v6, v6, 4, v7
  v_bfe_u32 v7, v5, 2, 2
  v_lshlrev_b32 v7, 3, v7
  v_lshrrev_b32 v8, 4, v5
  v_lshl_add_u32 v7, v8, 2, v7
  v_and_b32 v8, 3, v5
  v_add_u32 v7, v7, v8
  v_mul_u32_u24 v7, 3840, v7
  v_add_u32 v22, v6, v7
  v_add_u32 v4, 832, v1
  v_mul_u32_u24 v5, 2185, v4
  v_lshrrev_b32 v5, 16, v5
  v_mul_u32_u24 v6, 30, v5
  v_sub_u32 v6, v4, v6
  v_mul_u32_u24 v7, 6554, v6
  v_lshrrev_b32 v7, 16, v7
  v_mul_u32_u24 v8, 10, v7
  v_sub_u32 v6, v6, v8
  v_mul_u32_u24 v7, 1280, v7
  v_lshl_add_u32 v6, v6, 4, v7
  v_bfe_u32 v7, v5, 2, 2
  v_lshlrev_b32 v7, 3, v7
  v_lshrrev_b32 v8, 4, v5
  v_lshl_add_u32 v7, v8, 2, v7
  v_and_b32 v8, 3, v5
  v_add_u32 v7, v7, v8
  v_mul_u32_u24 v7, 3840, v7
  v_add_u32 v23, v6, v7
  v_add_u32 v4, 896, v1
  v_mul_u32_u24 v5, 2185, v4
  v_lshrrev_b32 v5, 16, v5
  v_mul_u32_u24 v6, 30, v5
  v_sub_u32 v6, v4, v6
  v_mul_u32_u24 v7, 6554, v6
  v_lshrrev_b32 v7, 16, v7
  v_mul_u32_u24 v8, 10, v7
  v_sub_u32 v6, v6, v8
  v_mul_u32_u24 v7, 1280, v7
  v_lshl_add_u32 v6, v6, 4, v7
  v_bfe_u32 v7, v5, 2, 2
  v_lshlrev_b32 v7, 3, v7
  v_lshrrev_b32 v8, 4, v5
  v_lshl_add_u32 v7, v8, 2, v7
  v_and_b32 v8, 3, v5
  v_add_u32 v7, v7, v8
  v_mul_u32_u24 v7, 3840, v7
  v_add_u32 v24, v6, v7
  s_mov_b32 s34, 0
  s_mov_b32 s36, 2
P1_QL3_S_0:
  s_add_u32 m0, s34, 9216
  s_nop 0
  buffer_load_dwordx4 v19, s[20:23], s33 offen  lds
  s_add_u32 m0, s34, 10240
  s_nop 0
  buffer_load_dwordx4 v20, s[20:23], s33 offen  lds
  s_add_u32 m0, s34, 11264
  s_nop 0
  buffer_load_dwordx4 v21, s[20:23], s33 offen  lds
  s_add_u32 m0, s34, 12288
  s_nop 0
  buffer_load_dwordx4 v22, s[20:23], s33 offen  lds
  s_add_u32 m0, s34, 13312
  s_nop 0
  buffer_load_dwordx4 v23, s[20:23], s33 offen  lds
  s_add_u32 m0, s34, 14336
  s_nop 0
  buffer_load_dwordx4 v24, s[20:23], s33 offen  lds
  s_add_u32 s31, s31, 1024
  s_add_u32 s32, s32, 1024
  s_add_u32 s33, s33, 122880
  s_add_u32 s34, s34, 24576
  s_cmp_eq_u32 s34, 73728
  s_cselect_b32 s34, 0, s34
  s_sub_u32 s36, s36, 1
  s_cmp_lg_u32 s36, 0
  s_cbranch_scc1 P1_QL3_S_0
  s_mov_b32 s36, 18
P1_QL3_S_1:
  s_waitcnt vmcnt(6)
  s_barrier
  s_add_u32 m0, s34, 9216
  s_nop 0
  buffer_load_dwordx4 v19, s[20:23], s33 offen  lds
  s_add_u32 m0, s34, 10240
  s_nop 0
  buffer_load_dwordx4 v20, s[20:23], s33 offen  lds
  s_add_u32 m0, s34, 11264
  s_nop 0
  buffer_load_dwordx4 v21, s[20:23], s33 offen  lds
  s_add_u32 m0, s34, 12288
  s_nop 0
  buffer_load_dwordx4 v22, s[20:23], s33 offen  lds
  s_add_u32 m0, s34, 13312
  s_nop 0
  buffer_load_dwordx4 v23, s[20:23], s33 offen  lds
  s_add_u32 m0, s34, 14336
  s_nop 0
  buffer_load_dwordx4 v24, s[20:23], s33 offen  lds
  s_add_u32 s31, s31, 1024
  s_add_u32 s32, s32, 1024
  s_add_u32 s33, s33, 122880
  s_add_u32 s34, s34, 24576
  s_cmp_eq_u32 s34, 73728
  s_cselect_b32 s34, 0, s34
  s_sub_u32 s36, s36, 1
  s_cmp_lg_u32 s36, 0
  s_cbranch_scc1 P1_QL3_S_1
  s_waitcnt vmcnt(6)
  s_barrier
  s_waitcnt vmcnt(0)
  s_barrier
  s_mov_b32 s44, s84
  s_and_b32 s45, s85, 0xffff
  s_mov_b32 s46, 7077888
  s_mov_b32 s47, 0x20000
  s_lshr_b32 s38, s2, 3
  s_cmp_ge_u32 s38, 27
  s_cbranch_scc1 P1_NOPF2345
  s_cmp_lg_u32 s24, 4
  s_cbranch_scc1 P1_NOPF2345
  s_mul_i32 s38, s38, 262144
  s_lshr_b32 s39, s84, 7
  s_sub_u32 s39, 3, s39
  s_and_b32 s39, s39, 7
  s_lshl_b32 s39, s39, 7
  s_add_u32 s38, s38, s39
  s_and_b32 s39, s2, 7
  s_lshr_b32 s39, s39, 1
  s_lshl_b32 s39, s39, 10
  s_add_u32 s38, s38, s39
  v_lshlrev_b32 v252, 12, v1
  buffer_load_dword v253, v252, s[44:47], s38 offen
P1_NOPF2345:
  s_barrier
  s_branch P3_ENTRY
P1_QC:
  v_lshlrev_b32 v2, 4, v1
  v_lshrrev_b32 v5, 2, v1
  v_mul_u32_u24 v5, 480, v5
  v_and_b32 v6, 3, v1
  s_mul_i32 s30, s24, 40
  v_add_u32 v5, s30, v5
  v_lshl_add_u32 v3, v6, 3, v5
  v_min_u32 v6, 2, v6
  v_mul_u32_u24 v6, 160, v6
  v_add3_u32 v4, v5, v6, 32
  v_mov_b32 v8, 0
  v_mov_b32 v9, 0
  v_mov_b32 v10, 0
  v_mov_b32 v11, 0
  v_mov_b32 v12, 0
  v_mov_b32 v13, 0
  v_mov_b32 v14, 0
  v_mov_b32 v15, 0
  v_mov_b32 v16, 0
  v_mov_b32 v17, 0
  v_mov_b32 v18, 0
  v_mov_b32 v19, 0
  v_mov_b32 v20, 0
  v_mov_b32 v21, 0
  v_mov_b32 v22, 0
  v_mov_b32 v23, 0
  v_mov_b32 v24, 0
  v_mov_b32 v25, 0
  v_mov_b32 v26, 0
  v_mov_b32 v27, 0
  v_mov_b32 v28, 0
  v_mov_b32 v29, 0
  v_mov_b32 v30, 0
  v_mov_b32 v31, 0
  v_mov_b32 v32, 0
  v_mov_b32 v33, 0
  v_mov_b32 v34, 0
  v_mov_b32 v35, 0
  v_mov_b32 v36, 0
  v_mov_b32 v37, 0
  v_mov_b32 v38, 0
  v_mov_b32 v39, 0
  v_mov_b32 v40, 0
  v_mov_b32 v41, 0
  v_mov_b32 v42, 0
  v_mov_b32 v43, 0
  v_mov_b32 v44, 0
  v_mov_b32 v45, 0
  v_mov_b32 v46, 0
  v_mov_b32 v47, 0
  v_mov_b32 v48, 0
  v_mov_b32 v49, 0
  v_mov_b32 v50, 0
  v_mov_b32 v51, 0
  v_mov_b32 v52, 0
  v_mov_b32 v53, 0
  v_mov_b32 v54, 0
  v_mov_b32 v55, 0
  v_mov_b32 v56, 0
  v_mov_b32 v57, 0
  v_mov_b32 v58, 0
  v_mov_b32 v59, 0
  v_mov_b32 v60, 0
  v_mov_b32 v61, 0
  v_mov_b32 v62, 0
  v_mov_b32 v63, 0
  v_mov_b32 v64, 0
  v_mov_b32 v65, 0
  v_mov_b32 v66, 0
  v_mov_b32 v67, 0
  v_mov_b32 v68, 0
  v_mov_b32 v69, 0
  v_mov_b32 v70, 0
  v_mov_b32 v71, 0
  v_mov_b32 v72, 0
  v_mov_b32 v73, 0
  v_mov_b32 v74, 0
  v_mov_b32 v75, 0
  v_mov_b32 v76, 0
  v_mov_b32 v77, 0
  v_mov_b32 v78, 0
  v_mov_b32 v79, 0
  v_mov_b32 v80, 0
  v_mov_b32 v81, 0
  v_mov_b32 v82, 0
  v_mov_b32 v83, 0
  v_mov_b32 v84, 0
  v_mov_b32 v85, 0
  v_mov_b32 v86, 0
  v_mov_b32 v87, 0
  v_mov_b32 v88, 0
  v_mov_b32 v89, 0
  v_mov_b32 v90, 0
  v_mov_b32 v91, 0
  v_mov_b32 v92, 0
  v_mov_b32 v93, 0
  v_mov_b32 v94, 0
  v_mov_b32 v95, 0
  v_mov_b32 v96, 0
  v_mov_b32 v97, 0
  v_mov_b32 v98, 0
  v_mov_b32 v99, 0
  v_mov_b32 v100, 0
  v_mov_b32 v101, 0
  v_mov_b32 v102, 0
  v_mov_b32 v103, 0
  v_mov_b32 v104, 0
  v_mov_b32 v105, 0
  v_mov_b32 v106, 0
  v_mov_b32 v107, 0
  v_mov_b32 v108, 0
  v_mov_b32 v109, 0
  v_mov_b32 v110, 0
  v_mov_b32 v111, 0
  v_mov_b32 v112, 0
  v_mov_b32 v113, 0
  v_mov_b32 v114, 0
  v_mov_b32 v115, 0
  v_mov_b32 v116, 0
  v_mov_b32 v117, 0
  v_mov_b32 v118, 0
  v_mov_b32 v119, 0
  v_mov_b32 v120, 0
  v_mov_b32 v121, 0
  v_mov_b32 v122, 0
  v_mov_b32 v123, 0
  v_mov_b32 v124, 0
  v_mov_b32 v125, 0
  v_mov_b32 v126, 0
  v_mov_b32 v127, 0
  v_mov_b32 v128, 0
  v_mov_b32 v129, 0
  v_mov_b32 v130, 0
  v_mov_b32 v131, 0
  v_mov_b32 v132, 0
  v_mov_b32 v133, 0
  v_mov_b32 v134, 0
  v_mov_b32 v135, 0
  v_mov_b32 v136, 0
  v_mov_b32 v137, 0
  v_mov_b32 v138, 0
  v_mov_b32 v139, 0
  v_mov_b32 v140, 0
  v_mov_b32 v141, 0
  v_mov_b32 v142, 0
  v_mov_b32 v143, 0
  v_mov_b32 v144, 0
  v_mov_b32 v145, 0
  v_mov_b32 v146, 0
  v_mov_b32 v147, 0
  v_mov_b32 v148, 0
  v_mov_b32 v149, 0
  v_mov_b32 v150, 0
  v_mov_b32 v151, 0
  v_mov_b32 v168, 0
  v_mov_b32 v169, 0
  v_mov_b32 v170, 0
  v_mov_b32 v171, 0
  v_mov_b32 v172, 0
  v_mov_b32 v173, 0
  v_mov_b32 v174, 0
  v_mov_b32 v175, 0
  v_mov_b32 v176, 0
  v_mov_b32 v177, 0
  v_mov_b32 v178, 0
  v_mov_b32 v179, 0
  v_mov_b32 v180, 0
  v_mov_b32 v181, 0
  v_mov_b32 v182, 0
  v_mov_b32 v183, 0
  v_mov_b32 v196, 0
  v_mov_b32 v197, 0
  v_mov_b32 v198, 0
  v_mov_b32 v199, 0
  v_mov_b32 v200, 0
  v_mov_b32 v201, 0
  v_mov_b32 v202, 0
  v_mov_b32 v203, 0
  v_mov_b32 v204, 0
  v_mov_b32 v205, 0
  v_mov_b32 v206, 0
  v_mov_b32 v207, 0
  v_and_b32 v5, 15, v1
  v_lshrrev_b32 v6, 4, v1
  v_mov_b32 v7, 0xf149f2ca
  v_mov_b32 v232, 0x3ea52b5c
  v_mov_b32 v233, 0xbea52b5c
  v_lshl_add_u32 v236, v6, 2, 0
  v_sub_u32 v237, v5, v236
  v_and_b32 v238, 1, v237
  v_cmp_eq_u32 s[40:41], 0, v238
  v_cmp_le_i32 s[42:43], 0, v237
  v_cmp_ge_i32 s[44:45], -2, v237
  s_and_b64 s[42:43], s[42:43], s[40:41]
  s_and_b64 s[44:45], s[44:45], s[40:41]
  v_cndmask_b32 v224, v7, 0, s[42:43]
  v_cndmask_b32 v220, v7, 0, s[44:45]
  v_lshl_add_u32 v236, v6, 2, 1
  v_sub_u32 v237, v5, v236
  v_and_b32 v238, 1, v237
  v_cmp_eq_u32 s[40:41], 0, v238
  v_cmp_le_i32 s[42:43], 0, v237
  v_cmp_ge_i32 s[44:45], -2, v237
  s_and_b64 s[42:43], s[42:43], s[40:41]
  s_and_b64 s[44:45], s[44:45], s[40:41]
  v_cndmask_b32 v225, v7, 0, s[42:43]
  v_cndmask_b32 v221, v7, 0, s[44:45]
  v_lshl_add_u32 v236, v6, 2, 2
  v_sub_u32 v237, v5, v236
  v_and_b32 v238, 1, v237
  v_cmp_eq_u32 s[40:41], 0, v238
  v_cmp_le_i32 s[42:43], 0, v237
  v_cmp_ge_i32 s[44:45], -2, v237
  s_and_b64 s[42:43], s[42:43], s[40:41]
  s_and_b64 s[44:45], s[44:45], s[40:41]
  v_cndmask_b32 v226, v7, 0, s[42:43]
  v_cndmask_b32 v222, v7, 0, s[44:45]
  v_lshl_add_u32 v236, v6, 2, 3
  v_sub_u32 v237, v5, v236
  v_and_b32 v238, 1, v237
  v_cmp_eq_u32 s[40:41], 0, v238
  v_cmp_le_i32 s[42:43], 0, v237
  v_cmp_ge_i32 s[44:45], -2, v237
  s_and_b64 s[42:43], s[42:43], s[40:41]
  s_and_b64 s[44:45], s[44:45], s[40:41]
  v_cndmask_b32 v227, v7, 0, s[42:43]
  v_cndmask_b32 v223, v7, 0, s[44:45]
  v_mov_b32 v216, 0x3f803f80
  v_mov_b32 v217, 0x3f803f80
  v_mov_b32 v218, 0x3f803f80
  v_mov_b32 v219, 0x3f803f80
  s_cmp_eq_u32 s25, 0
  s_cselect_b64 s[40:41], -1, 0
  v_cndmask_b32 v228, v220, v7, s[40:41]
  v_cndmask_b32 v229, v221, v7, s[40:41]
  v_cndmask_b32 v230, v222, v7, s[40:41]
  v_cndmask_b32 v231, v223, v7, s[40:41]
  v_mov_b32 v212, 0
  v_mov_b32 v213, 0
  v_mov_b32 v236, 0x3f80
  v_mov_b32 v237, 0x3f800000
  v_mov_b32 v214, 0
  v_mov_b32 v215, 0
  v_cmp_eq_u32 vcc, 32, v1
  s_nop 1
  v_cndmask_b32 v214, v214, v236, vcc
  v_cmp_eq_u32 vcc, 33, v1
  s_nop 1
  v_cndmask_b32 v214, v214, v237, vcc
  v_cmp_eq_u32 vcc, 34, v1
  s_nop 1
  v_cndmask_b32 v215, v215, v236, vcc
  v_cmp_eq_u32 vcc, 35, v1
  s_nop 1
  v_cndmask_b32 v215, v215, v237, vcc
  s_mov_b32 s46, 0
  s_mov_b32 s47, 0xffff0000
  s_lshl_b32 s30, s26, 2
  s_add_u32 s30, s30, s24
  s_lshr_b32 s31, s30, 3
  s_and_b32 s30, s30, 7
  s_mul_i32 s31, s31, 5
  s_mul_i32 s32, s25, 80
  s_add_u32 s31, s31, s32
  s_lshr_b32 s32, s30, 1
  s_add_u32 s32, s32, s31
  s_lshl_b32 s32, s32, 11
  s_and_b32 s33, s30, 1
  s_lshl_b32 s33, s33, 10
  s_add_u32 s32, s32, s33
  s_add_u32 s32, s32, 8388608
  s_add_u32 s31, s31, 4
  s_lshl_b32 s31, s31, 11
  s_and_b32 s33, s30, 3
  s_lshl_b32 s33, s33, 8
  s_add_u32 s31, s31, s33
  s_lshr_b32 s33, s30, 2
  s_lshl_b32 s33, s33, 10
  s_add_u32 s31, s31, s33
  s_add_u32 s31, s31, 8388608
  v_mov_b32 v234, 0x10000000
  v_cmp_gt_u32 vcc, 16, v1
  s_nop 1
  v_cndmask_b32 v234, v234, v2, vcc
  s_mov_b32 s34, 0
  s_mov_b32 s36, 15360
  s_mov_b32 s35, 10
  v_add_u32 v211, 15360, v2
P1_QCL:
  s_barrier
  v_add_u32 v208, s34, v211
  v_add_u32 v209, s34, v3
  v_add_u32 v210, s34, v4
  v_mfma_f32_16x16x32_bf16 v[104:107], v[168:171], v[196:199], v[104:107]
  ds_read_b64_tr_b16 v[152:153], v209 offset:0
  v_mfma_f32_16x16x32_bf16 v[108:111], v[172:175], v[196:199], v[108:111]
  ds_read_b64_tr_b16 v[154:155], v209 offset:7680
  v_mfma_f32_16x16x32_bf16 v[112:115], v[176:179], v[196:199], v[112:115]
  ds_read_b128 v[184:187], v208 offset:0
  v_mfma_f32_16x16x32_bf16 v[116:119], v[196:199], v[180:183], v[116:119]
  ds_read_b64_tr_b16 v[156:157], v209 offset:160
  v_mfma_f32_16x16x32_bf16 v[120:123], v[168:171], v[200:203], v[120:123]
  ds_read_b64_tr_b16 v[158:159], v209 offset:7840
  v_mfma_f32_16x16x32_bf16 v[124:127], v[172:175], v[200:203], v[124:127]
  ds_read_b64_tr_b16 v[160:161], v210 offset:0
  v_mfma_f32_16x16x32_bf16 v[128:131], v[176:179], v[200:203], v[128:131]
  ds_read_b64_tr_b16 v[162:163], v210 offset:7680
  v_mfma_f32_16x16x32_bf16 v[132:135], v[200:203], v[180:183], v[132:135]
  ds_read_b128 v[188:191], v208 offset:1024
  v_mfma_f32_16x16x32_bf16 v[136:139], v[168:171], v[204:207], v[136:139]
  ds_read_b64_tr_b16 v[164:165], v209 offset:320
  v_mfma_f32_16x16x32_bf16 v[140:143], v[172:175], v[204:207], v[140:143]
  ds_read_b64_tr_b16 v[166:167], v209 offset:8000
  v_mfma_f32_16x16x32_bf16 v[144:147], v[176:179], v[204:207], v[144:147]
  ds_read_b128 v[192:195], v208 offset:2048
  v_mfma_f32_16x16x32_bf16 v[148:151], v[204:207], v[180:183], v[148:151]
  ds_read_b128 v[196:199], v208 offset:3072
  s_add_u32 s34, s34, 24576
  s_cmp_eq_u32 s34, 73728
  s_cselect_b32 s34, 0, s34
  s_waitcnt lgkmcnt(7)
  v_mfma_f32_16x16x32_bf16 v[12:15], v[156:159], v[184:187], v[12:15]
  ds_read_b128 v[200:203], v208 offset:4096
  s_waitcnt lgkmcnt(6)
  v_mfma_f32_16x16x32_bf16 v[16:19], v[160:163], v[184:187], v[16:19]
  ds_read_b128 v[204:207], v208 offset:5120
  s_waitcnt lgkmcnt(4)
  v_mfma_f32_16x16x32_bf16 v[20:23], v[184:187], v[164:167], v[20:23]
  v_mfma_f32_16x16x32_bf16 v[24:27], v[152:155], v[188:191], v[24:27]
  ds_read_b128 v[184:187], v208 offset:6144
  v_mfma_f32_16x16x32_bf16 v[28:31], v[156:159], v[188:191], v[28:31]
  v_mfma_f32_16x16x32_bf16 v[32:35], v[160:163], v[188:191], v[32:35]
  v_mfma_f32_16x16x32_bf16 v[36:39], v[188:191], v[164:167], v[36:39]
  s_waitcnt lgkmcnt(4)
  v_mfma_f32_16x16x32_bf16 v[40:43], v[152:155], v[192:195], v[40:43]
  ds_read_b128 v[188:191], v208 offset:7168
  v_mfma_f32_16x16x32_bf16 v[44:47], v[156:159], v[192:195], v[44:47]
  v_mfma_f32_16x16x32_bf16 v[48:51], v[160:163], v[192:195], v[48:51]
  v_mfma_f32_16x16x32_bf16 v[52:55], v[192:195], v[164:167], v[52:55]
  s_waitcnt lgkmcnt(4)
  v_mfma_f32_16x16x32_bf16 v[56:59], v[152:155], v[196:199], v[56:59]
  ds_read_b128 v[192:195], v208 offset:8192
  v_mfma_f32_16x16x32_bf16 v[60:63], v[156:159], v[196:199], v[60:63]
  v_mfma_f32_16x16x32_bf16 v[64:67], v[160:163], v[196:199], v[64:67]
  v_mfma_f32_16x16x32_bf16 v[68:71], v[196:199], v[164:167], v[68:71]
  s_waitcnt lgkmcnt(4)
  v_mfma_f32_16x16x32_bf16 v[72:75], v[152:155], v[200:203], v[72:75]
  v_mfma_f32_16x16x32_bf16 v[76:79], v[156:159], v[200:203], v[76:79]
  v_mfma_f32_16x16x32_bf16 v[80:83], v[160:163], v[200:203], v[80:83]
  v_mfma_f32_16x16x32_bf16 v[84:87], v[200:203], v[164:167], v[84:87]
  s_waitcnt lgkmcnt(3)
  v_mfma_f32_16x16x32_bf16 v[88:91], v[152:155], v[204:207], v[88:91]
  v_mfma_f32_16x16x32_bf16 v[92:95], v[156:159], v[204:207], v[92:95]
  v_mfma_f32_16x16x32_bf16 v[96:99], v[160:163], v[204:207], v[96:99]
  v_mfma_f32_16x16x32_bf16 v[100:103], v[204:207], v[164:167], v[100:103]
  s_waitcnt lgkmcnt(0)
  s_barrier
  v_add_u32 v208, s34, v211
  v_add_u32 v209, s34, v3
  v_add_u32 v210, s34, v4
  v_mfma_f32_16x16x32_bf16 v[104:107], v[152:155], v[184:187], v[104:107]
  ds_read_b64_tr_b16 v[168:169], v209 offset:0
  v_mfma_f32_16x16x32_bf16 v[108:111], v[156:159], v[184:187], v[108:111]
  ds_read_b64_tr_b16 v[170:171], v209 offset:7680
  v_mfma_f32_16x16x32_bf16 v[112:115], v[160:163], v[184:187], v[112:115]
  ds_read_b128 v[196:199], v208 offset:0
  v_mfma_f32_16x16x32_bf16 v[116:119], v[184:187], v[164:167], v[116:119]
  ds_read_b64_tr_b16 v[172:173], v209 offset:160
  v_mfma_f32_16x16x32_bf16 v[120:123], v[152:155], v[188:191], v[120:123]
  ds_read_b64_tr_b16 v[174:175], v209 offset:7840
  v_mfma_f32_16x16x32_bf16 v[124:127], v[156:159], v[188:191], v[124:127]
  ds_read_b64_tr_b16 v[176:177], v210 offset:0
  v_mfma_f32_16x16x32_bf16 v[128:131], v[160:163], v[188:191], v[128:131]
  ds_read_b64_tr_b16 v[178:179], v210 offset:7680
  v_mfma_f32_16x16x32_bf16 v[132:135], v[188:191], v[164:167], v[132:135]
  ds_read_b128 v[200:203], v208 offset:1024
  v_mfma_f32_16x16x32_bf16 v[136:139], v[152:155], v[192:195], v[136:139]
  ds_read_b64_tr_b16 v[180:181], v209 offset:320
  v_mfma_f32_16x16x32_bf16 v[140:143], v[156:159], v[192:195], v[140:143]
  ds_read_b64_tr_b16 v[182:183], v209 offset:8000
  v_mfma_f32_16x16x32_bf16 v[144:147], v[160:163], v[192:195], v[144:147]
  ds_read_b128 v[204:207], v208 offset:2048
  v_mfma_f32_16x16x32_bf16 v[148:151], v[192:195], v[164:167], v[148:151]
  ds_read_b128 v[184:187], v208 offset:3072
  s_add_u32 s34, s34, 24576
  s_cmp_eq_u32 s34, 73728
  s_cselect_b32 s34, 0, s34
  s_waitcnt lgkmcnt(7)
  v_mfma_f32_16x16x32_bf16 v[12:15], v[172:175], v[196:199], v[12:15]
  ds_read_b128 v[188:191], v208 offset:4096
  s_waitcnt lgkmcnt(6)
  v_mfma_f32_16x16x32_bf16 v[16:19], v[176:179], v[196:199], v[16:19]
  ds_read_b128 v[192:195], v208 offset:5120
  s_waitcnt lgkmcnt(4)
  v_mfma_f32_16x16x32_bf16 v[20:23], v[196:199], v[180:183], v[20:23]
  v_mfma_f32_16x16x32_bf16 v[24:27], v[168:171], v[200:203], v[24:27]
  ds_read_b128 v[196:199], v208 offset:6144
  v_mfma_f32_16x16x32_bf16 v[28:31], v[172:175], v[200:203], v[28:31]
  v_mfma_f32_16x16x32_bf16 v[32:35], v[176:179], v[200:203], v[32:35]
  v_mfma_f32_16x16x32_bf16 v[36:39], v[200:203], v[180:183], v[36:39]
  s_waitcnt lgkmcnt(4)
  v_mfma_f32_16x16x32_bf16 v[40:43], v[168:171], v[204:207], v[40:43]
  ds_read_b128 v[200:203], v208 offset:7168
  v_mfma_f32_16x16x32_bf16 v[44:47], v[172:175], v[204:207], v[44:47]
  v_mfma_f32_16x16x32_bf16 v[48:51], v[176:179], v[204:207], v[48:51]
  v_mfma_f32_16x16x32_bf16 v[52:55], v[204:207], v[180:183], v[52:55]
  s_waitcnt lgkmcnt(4)
  v_mfma_f32_16x16x32_bf16 v[56:59], v[168:171], v[184:187], v[56:59]
  ds_read_b128 v[204:207], v208 offset:8192
  v_mfma_f32_16x16x32_bf16 v[60:63], v[172:175], v[184:187], v[60:63]
  v_mfma_f32_16x16x32_bf16 v[64:67], v[176:179], v[184:187], v[64:67]
  v_mfma_f32_16x16x32_bf16 v[68:71], v[184:187], v[180:183], v[68:71]
  s_waitcnt lgkmcnt(4)
  v_mfma_f32_16x16x32_bf16 v[72:75], v[168:171], v[188:191], v[72:75]
  v_mfma_f32_16x16x32_bf16 v[76:79], v[172:175], v[188:191], v[76:79]
  v_mfma_f32_16x16x32_bf16 v[80:83], v[176:179], v[188:191], v[80:83]
  v_mfma_f32_16x16x32_bf16 v[84:87], v[188:191], v[180:183], v[84:87]
  s_waitcnt lgkmcnt(3)
  v_mfma_f32_16x16x32_bf16 v[88:91], v[168:171], v[192:195], v[88:91]
  v_mfma_f32_16x16x32_bf16 v[92:95], v[172:175], v[192:195], v[92:95]
  v_mfma_f32_16x16x32_bf16 v[96:99], v[176:179], v[192:195], v[96:99]
  v_mfma_f32_16x16x32_bf16 v[100:103], v[192:195], v[180:183], v[100:103]
  s_waitcnt lgkmcnt(0)
  s_sub_u32 s35, s35, 1
  s_cmp_lg_u32 s35, 0
  s_cbranch_scc1 P1_QCL
  s_barrier
  v_mfma_f32_16x16x32_bf16 v[104:107], v[168:171], v[196:199], v[104:107]
  v_mfma_f32_16x16x32_bf16 v[108:111], v[172:175], v[196:199], v[108:111]
  v_mfma_f32_16x16x32_bf16 v[112:115], v[176:179], v[196:199], v[112:115]
  v_mfma_f32_16x16x32_bf16 v[116:119], v[196:199], v[180:183], v[116:119]
  v_mfma_f32_16x16x32_bf16 v[120:123], v[168:171], v[200:203], v[120:123]
  v_mfma_f32_16x16x32_bf16 v[124:127], v[172:175], v[200:203], v[124:127]
  v_mfma_f32_16x16x32_bf16 v[128:131], v[176:179], v[200:203], v[128:131]
  v_mfma_f32_16x16x32_bf16 v[132:135], v[200:203], v[180:183], v[132:135]
  v_mfma_f32_16x16x32_bf16 v[136:139], v[168:171], v[204:207], v[136:139]
  v_mfma_f32_16x16x32_bf16 v[140:143], v[172:175], v[204:207], v[140:143]
  v_mfma_f32_16x16x32_bf16 v[144:147], v[176:179], v[204:207], v[144:147]
  v_mfma_f32_16x16x32_bf16 v[148:151], v[204:207], v[180:183], v[148:151]
  v_cvt_pk_bf16_f32 v8, v8, v9
  v_cvt_pk_bf16_f32 v24, v24, v25
  v_cvt_pk_bf16_f32 v40, v40, v41
  v_cvt_pk_bf16_f32 v9, v10, v11
  v_cvt_pk_bf16_f32 v25, v26, v27
  v_cvt_pk_bf16_f32 v41, v42, v43
  v_cvt_pk_bf16_f32 v10, v16, v17
  v_cvt_pk_bf16_f32 v26, v32, v33
  v_cvt_pk_bf16_f32 v42, v48, v49
  v_cvt_pk_bf16_f32 v11, v18, v19
  v_cvt_pk_bf16_f32 v27, v34, v35
  v_cvt_pk_bf16_f32 v43, v50, v51
  v_cvt_pk_bf16_f32 v12, v12, v13
  v_cvt_pk_bf16_f32 v28, v28, v29
  v_cvt_pk_bf16_f32 v44, v44, v45
  v_cvt_pk_bf16_f32 v13, v14, v15
  v_cvt_pk_bf16_f32 v29, v30, v31
  v_cvt_pk_bf16_f32 v45, v46, v47
  v_cndmask_b32 v10, v10, 0, s[46:47]
  v_cndmask_b32 v26, v26, 0, s[46:47]
  v_cndmask_b32 v42, v42, 0, s[46:47]
  v_cndmask_b32 v11, v11, 0, s[46:47]
  v_cndmask_b32 v27, v27, 0, s[46:47]
  v_cndmask_b32 v43, v43, 0, s[46:47]
  v_mov_b32 v14, 0
  v_mov_b32 v30, 0
  v_mov_b32 v46, 0
  v_mov_b32 v15, 0
  v_mov_b32 v31, 0
  v_mov_b32 v47, 0
  v_cvt_pk_bf16_f32 v152, v20, v21
  v_cvt_pk_bf16_f32 v154, v36, v37
  v_cvt_pk_bf16_f32 v156, v52, v53
  v_cvt_pk_bf16_f32 v153, v22, v23
  v_cvt_pk_bf16_f32 v155, v38, v39
  v_cvt_pk_bf16_f32 v157, v54, v55
  v_permlane16_swap_b32 v10, v14
  v_permlane16_swap_b32 v26, v30
  v_permlane16_swap_b32 v42, v46
  v_permlane16_swap_b32 v11, v15
  v_permlane16_swap_b32 v27, v31
  v_permlane16_swap_b32 v43, v47
  v_mfma_f32_16x16x32_bf16 v[16:19], v[8:11], v[212:215], 0
  v_mfma_f32_16x16x32_bf16 v[32:35], v[24:27], v[212:215], 0
  v_mfma_f32_16x16x32_bf16 v[48:51], v[40:43], v[212:215], 0
  v_cvt_pk_bf16_f32 v56, v56, v57
  v_cvt_pk_bf16_f32 v72, v72, v73
  v_cvt_pk_bf16_f32 v88, v88, v89
  v_cvt_pk_bf16_f32 v57, v58, v59
  v_cvt_pk_bf16_f32 v73, v74, v75
  v_cvt_pk_bf16_f32 v89, v90, v91
  v_cvt_pk_bf16_f32 v58, v64, v65
  v_cvt_pk_bf16_f32 v74, v80, v81
  v_cvt_pk_bf16_f32 v90, v96, v97
  v_cvt_pk_bf16_f32 v59, v66, v67
  v_cvt_pk_bf16_f32 v75, v82, v83
  v_cvt_pk_bf16_f32 v91, v98, v99
  v_cvt_pk_bf16_f32 v60, v60, v61
  v_cvt_pk_bf16_f32 v76, v76, v77
  v_cvt_pk_bf16_f32 v92, v92, v93
  v_cvt_pk_bf16_f32 v61, v62, v63
  v_cvt_pk_bf16_f32 v77, v78, v79
  v_cvt_pk_bf16_f32 v93, v94, v95
  v_cndmask_b32 v58, v58, 0, s[46:47]
  v_cndmask_b32 v74, v74, 0, s[46:47]
  v_cndmask_b32 v90, v90, 0, s[46:47]
  v_cndmask_b32 v59, v59, 0, s[46:47]
  v_cndmask_b32 v75, v75, 0, s[46:47]
  v_cndmask_b32 v91, v91, 0, s[46:47]
  v_mov_b32 v62, 0
  v_mov_b32 v78, 0
  v_mov_b32 v94, 0
  v_mov_b32 v63, 0
  v_mov_b32 v79, 0
  v_mov_b32 v95, 0
  v_cvt_pk_bf16_f32 v158, v68, v69
  v_cvt_pk_bf16_f32 v160, v84, v85
  v_cvt_pk_bf16_f32 v162, v100, v101
  v_cvt_pk_bf16_f32 v159, v70, v71
  v_cvt_pk_bf16_f32 v161, v86, v87
  v_cvt_pk_bf16_f32 v163, v102, v103
  v_permlane16_swap_b32 v58, v62
  v_permlane16_swap_b32 v74, v78
  v_permlane16_swap_b32 v90, v94
  v_permlane16_swap_b32 v59, v63
  v_permlane16_swap_b32 v75, v79
  v_permlane16_swap_b32 v91, v95
  v_mfma_f32_16x16x32_bf16 v[64:67], v[56:59], v[212:215], 0
  v_mfma_f32_16x16x32_bf16 v[80:83], v[72:75], v[212:215], 0
  v_mfma_f32_16x16x32_bf16 v[96:99], v[88:91], v[212:215], 0
  v_cvt_pk_bf16_f32 v104, v104, v105
  v_cvt_pk_bf16_f32 v120, v120, v121
  v_cvt_pk_bf16_f32 v136, v136, v137
  v_cvt_pk_bf16_f32 v105, v106, v107
  v_cvt_pk_bf16_f32 v121, v122, v123
  v_cvt_pk_bf16_f32 v137, v138, v139
  v_cvt_pk_bf16_f32 v106, v112, v113
  v_cvt_pk_bf16_f32 v122, v128, v129
  v_cvt_pk_bf16_f32 v138, v144, v145
  v_cvt_pk_bf16_f32 v107, v114, v115
  v_cvt_pk_bf16_f32 v123, v130, v131
  v_cvt_pk_bf16_f32 v139, v146, v147
  v_cvt_pk_bf16_f32 v108, v108, v109
  v_cvt_pk_bf16_f32 v124, v124, v125
  v_cvt_pk_bf16_f32 v140, v140, v141
  v_cvt_pk_bf16_f32 v109, v110, v111
  v_cvt_pk_bf16_f32 v125, v126, v127
  v_cvt_pk_bf16_f32 v141, v142, v143
  v_cndmask_b32 v106, v106, 0, s[46:47]
  v_cndmask_b32 v122, v122, 0, s[46:47]
  v_cndmask_b32 v138, v138, 0, s[46:47]
  v_cndmask_b32 v107, v107, 0, s[46:47]
  v_cndmask_b32 v123, v123, 0, s[46:47]
  v_cndmask_b32 v139, v139, 0, s[46:47]
  v_mov_b32 v110, 0
  v_mov_b32 v126, 0
  v_mov_b32 v142, 0
  v_mov_b32 v111, 0
  v_mov_b32 v127, 0
  v_mov_b32 v143, 0
  v_cvt_pk_bf16_f32 v164, v116, v117
  v_cvt_pk_bf16_f32 v166, v132, v133
  v_cvt_pk_bf16_f32 v168, v148, v149
  v_cvt_pk_bf16_f32 v165, v118, v119
  v_cvt_pk_bf16_f32 v167, v134, v135
  v_cvt_pk_bf16_f32 v169, v150, v151
  v_permlane16_swap_b32 v106, v110
  v_permlane16_swap_b32 v122, v126
  v_permlane16_swap_b32 v138, v142
  v_permlane16_swap_b32 v107, v111
  v_permlane16_swap_b32 v123, v127
  v_permlane16_swap_b32 v139, v143
  v_mfma_f32_16x16x32_bf16 v[112:115], v[104:107], v[212:215], 0
  v_mfma_f32_16x16x32_bf16 v[128:131], v[120:123], v[212:215], 0
  v_mfma_f32_16x16x32_bf16 v[144:147], v[136:139], v[212:215], 0
  v_cvt_pk_bf16_f32 v170, v16, v17
  v_cvt_pk_bf16_f32 v171, v18, v19
  v_cvt_pk_bf16_f32 v172, v32, v33
  v_cvt_pk_bf16_f32 v173, v34, v35
  v_cvt_pk_bf16_f32 v174, v48, v49
  v_cvt_pk_bf16_f32 v175, v50, v51
  v_cvt_pk_bf16_f32 v176, v64, v65
  v_cvt_pk_bf16_f32 v177, v66, v67
  v_cvt_pk_bf16_f32 v178, v80, v81
  v_cvt_pk_bf16_f32 v179, v82, v83
  v_cvt_pk_bf16_f32 v180, v96, v97
  v_cvt_pk_bf16_f32 v181, v98, v99
  v_cvt_pk_bf16_f32 v182, v112, v113
  v_cvt_pk_bf16_f32 v183, v114, v115
  v_cvt_pk_bf16_f32 v184, v128, v129
  v_cvt_pk_bf16_f32 v185, v130, v131
  v_cvt_pk_bf16_f32 v186, v144, v145
  v_cvt_pk_bf16_f32 v187, v146, v147
  v_mfma_f32_16x16x32_bf16 v[36:39], v[12:15], v[24:27], v[228:231]
  v_mfma_f32_16x16x32_bf16 v[52:55], v[28:31], v[40:43], v[220:223]
  v_mfma_f32_16x16x32_bf16 v[32:35], v[28:31], v[24:27], v[224:227]
  v_mfma_f32_16x16x32_bf16 v[48:51], v[44:47], v[40:43], v[224:227]
  s_nop 4
  v_max3_f32 v188, v36, v37, v38
  v_max3_f32 v190, v52, v53, v54
  v_max3_f32 v189, v39, v32, v33
  v_max3_f32 v191, v55, v48, v49
  v_max3_f32 v188, v188, v34, v35
  v_max3_f32 v190, v190, v50, v51
  v_max_f32 v188, v188, v189
  v_max_f32 v190, v190, v191
  v_mov_b32 v189, v188
  v_mov_b32 v191, v190
  s_nop 0
  v_permlane32_swap_b32 v188, v189
  v_permlane32_swap_b32 v190, v191
  v_max_f32 v188, v188, v189
  v_max_f32 v190, v190, v191
  v_mov_b32 v189, v188
  v_mov_b32 v191, v190
  s_nop 0
  v_permlane16_swap_b32 v188, v189
  v_permlane16_swap_b32 v190, v191
  v_max_f32 v188, v188, v189
  v_max_f32 v190, v190, v191
  v_mul_f32 v188, v233, v188
  v_mul_f32 v190, v233, v190
  v_pk_fma_f32 v[36:37], v[36:37], v[232:233], v[188:189] op_sel_hi:[1,0,0]
  v_pk_fma_f32 v[52:53], v[52:53], v[232:233], v[190:191] op_sel_hi:[1,0,0]
  v_pk_fma_f32 v[38:39], v[38:39], v[232:233], v[188:189] op_sel_hi:[1,0,0]
  v_pk_fma_f32 v[54:55], v[54:55], v[232:233], v[190:191] op_sel_hi:[1,0,0]
  v_pk_fma_f32 v[32:33], v[32:33], v[232:233], v[188:189] op_sel_hi:[1,0,0]
  v_pk_fma_f32 v[48:49], v[48:49], v[232:233], v[190:191] op_sel_hi:[1,0,0]
  v_pk_fma_f32 v[34:35], v[34:35], v[232:233], v[188:189] op_sel_hi:[1,0,0]
  v_pk_fma_f32 v[50:51], v[50:51], v[232:233], v[190:191] op_sel_hi:[1,0,0]
  v_exp_f32 v36, v36
  v_exp_f32 v52, v52
  v_exp_f32 v37, v37
  v_exp_f32 v53, v53
  v_exp_f32 v38, v38
  v_exp_f32 v54, v54
  v_exp_f32 v39, v39
  v_exp_f32 v55, v55
  v_exp_f32 v32, v32
  v_exp_f32 v48, v48
  v_exp_f32 v33, v33
  v_exp_f32 v49, v49
  v_exp_f32 v34, v34
  v_exp_f32 v50, v50
  v_exp_f32 v35, v35
  v_exp_f32 v51, v51
  v_cvt_pk_bf16_f32 v192, v36, v37
  v_cvt_pk_bf16_f32 v236, v52, v53
  v_cvt_pk_bf16_f32 v193, v38, v39
  v_cvt_pk_bf16_f32 v237, v54, v55
  v_cvt_pk_bf16_f32 v194, v32, v33
  v_cvt_pk_bf16_f32 v238, v48, v49
  v_cvt_pk_bf16_f32 v195, v34, v35
  v_cvt_pk_bf16_f32 v239, v50, v51
  s_nop 0
  v_mfma_f32_16x16x32_bf16 v[204:207], v[216:219], v[192:195], 0
  v_mfma_f32_16x16x32_bf16 v[248:251], v[216:219], v[236:239], 0
  v_mfma_f32_16x16x32_bf16 v[196:199], v[152:155], v[192:195], 0
  v_mfma_f32_16x16x32_bf16 v[240:243], v[154:157], v[236:239], 0
  v_mfma_f32_16x16x32_bf16 v[200:203], v[170:173], v[192:195], 0
  v_mfma_f32_16x16x32_bf16 v[244:247], v[172:175], v[236:239], 0
  s_nop 2
  v_rcp_f32 v204, v204
  v_rcp_f32 v248, v248
  v_pk_mul_f32 v[196:197], v[196:197], v[204:205] op_sel_hi:[1,0]
  v_pk_mul_f32 v[240:241], v[240:241], v[248:249] op_sel_hi:[1,0]
  v_pk_mul_f32 v[198:199], v[198:199], v[204:205] op_sel_hi:[1,0]
  v_pk_mul_f32 v[242:243], v[242:243], v[248:249] op_sel_hi:[1,0]
  v_pk_mul_f32 v[200:201], v[200:201], v[204:205] op_sel_hi:[1,0]
  v_pk_mul_f32 v[244:245], v[244:245], v[248:249] op_sel_hi:[1,0]
  v_pk_mul_f32 v[202:203], v[202:203], v[204:205] op_sel_hi:[1,0]
  v_pk_mul_f32 v[246:247], v[246:247], v[248:249] op_sel_hi:[1,0]
  v_cvt_pk_bf16_f32 v8, v196, v197
  v_cvt_pk_bf16_f32 v10, v240, v241
  v_cvt_pk_bf16_f32 v9, v198, v199
  v_cvt_pk_bf16_f32 v11, v242, v243
  v_cvt_pk_bf16_f32 v16, v200, v201
  v_cvt_pk_bf16_f32 v18, v244, v245
  v_cvt_pk_bf16_f32 v17, v202, v203
  v_cvt_pk_bf16_f32 v19, v246, v247
  s_add_u32 s48, s32, 0
  s_add_u32 s49, s31, 0
  buffer_store_dwordx4 v[8:11], v2, s[16:19], s48 offen sc1
  buffer_store_dwordx4 v[16:19], v234, s[16:19], s49 offen sc1
  v_mfma_f32_16x16x32_bf16 v[68:71], v[44:47], v[56:59], v[220:223]
  v_mfma_f32_16x16x32_bf16 v[84:87], v[60:63], v[72:75], v[220:223]
  v_mfma_f32_16x16x32_bf16 v[64:67], v[60:63], v[56:59], v[224:227]
  v_mfma_f32_16x16x32_bf16 v[80:83], v[76:79], v[72:75], v[224:227]
  s_nop 4
  v_max3_f32 v188, v68, v69, v70
  v_max3_f32 v190, v84, v85, v86
  v_max3_f32 v189, v71, v64, v65
  v_max3_f32 v191, v87, v80, v81
  v_max3_f32 v188, v188, v66, v67
  v_max3_f32 v190, v190, v82, v83
  v_max_f32 v188, v188, v189
  v_max_f32 v190, v190, v191
  v_mov_b32 v189, v188
  v_mov_b32 v191, v190
  s_nop 0
  v_permlane32_swap_b32 v188, v189
  v_permlane32_swap_b32 v190, v191
  v_max_f32 v188, v188, v189
  v_max_f32 v190, v190, v191
  v_mov_b32 v189, v188
  v_mov_b32 v191, v190
  s_nop 0
  v_permlane16_swap_b32 v188, v189
  v_permlane16_swap_b32 v190, v191
  v_max_f32 v188, v188, v189
  v_max_f32 v190, v190, v191
  v_mul_f32 v188, v233, v188
  v_mul_f32 v190, v233, v190
  v_pk_fma_f32 v[68:69], v[68:69], v[232:233], v[188:189] op_sel_hi:[1,0,0]
  v_pk_fma_f32 v[84:85], v[84:85], v[232:233], v[190:191] op_sel_hi:[1,0,0]
  v_pk_fma_f32 v[70:71], v[70:71], v[232:233], v[188:189] op_sel_hi:[1,0,0]
  v_pk_fma_f32 v[86:87], v[86:87], v[232:233], v[190:191] op_sel_hi:[1,0,0]
  v_pk_fma_f32 v[64:65], v[64:65], v[232:233], v[188:189] op_sel_hi:[1,0,0]
  v_pk_fma_f32 v[80:81], v[80:81], v[232:233], v[190:191] op_sel_hi:[1,0,0]
  v_pk_fma_f32 v[66:67], v[66:67], v[232:233], v[188:189] op_sel_hi:[1,0,0]
  v_pk_fma_f32 v[82:83], v[82:83], v[232:233], v[190:191] op_sel_hi:[1,0,0]
  v_exp_f32 v68, v68
  v_exp_f32 v84, v84
  v_exp_f32 v69, v69
  v_exp_f32 v85, v85
  v_exp_f32 v70, v70
  v_exp_f32 v86, v86
  v_exp_f32 v71, v71
  v_exp_f32 v87, v87
  v_exp_f32 v64, v64
  v_exp_f32 v80, v80
  v_exp_f32 v65, v65
  v_exp_f32 v81, v81
  v_exp_f32 v66, v66
  v_exp_f32 v82, v82
  v_exp_f32 v67, v67
  v_exp_f32 v83, v83
  v_cvt_pk_bf16_f32 v192, v68, v69
  v_cvt_pk_bf16_f32 v236, v84, v85
  v_cvt_pk_bf16_f32 v193, v70, v71
  v_cvt_pk_bf16_f32 v237, v86, v87
  v_cvt_pk_bf16_f32 v194, v64, v65
  v_cvt_pk_bf16_f32 v238, v80, v81
  v_cvt_pk_bf16_f32 v195, v66, v67
  v_cvt_pk_bf16_f32 v239, v82, v83
  s_nop 0
  v_mfma_f32_16x16x32_bf16 v[204:207], v[216:219], v[192:195], 0
  v_mfma_f32_16x16x32_bf16 v[248:251], v[216:219], v[236:239], 0
  v_mfma_f32_16x16x32_bf16 v[196:199], v[156:159], v[192:195], 0
  v_mfma_f32_16x16x32_bf16 v[240:243], v[158:161], v[236:239], 0
  v_mfma_f32_16x16x32_bf16 v[200:203], v[174:177], v[192:195], 0
  v_mfma_f32_16x16x32_bf16 v[244:247], v[176:179], v[236:239], 0
  s_nop 2
  v_rcp_f32 v204, v204
  v_rcp_f32 v248, v248
  v_pk_mul_f32 v[196:197], v[196:197], v[204:205] op_sel_hi:[1,0]
  v_pk_mul_f32 v[240:241], v[240:241], v[248:249] op_sel_hi:[1,0]
  v_pk_mul_f32 v[198:199], v[198:199], v[204:205] op_sel_hi:[1,0]
  v_pk_mul_f32 v[242:243], v[242:243], v[248:249] op_sel_hi:[1,0]
  v_pk_mul_f32 v[200:201], v[200:201], v[204:205] op_sel_hi:[1,0]
  v_pk_mul_f32 v[244:245], v[244:245], v[248:249] op_sel_hi:[1,0]
  v_pk_mul_f32 v[202:203], v[202:203], v[204:205] op_sel_hi:[1,0]
  v_pk_mul_f32 v[246:247], v[246:247], v[248:249] op_sel_hi:[1,0]
  v_cvt_pk_bf16_f32 v8, v196, v197
  v_cvt_pk_bf16_f32 v10, v240, v241
  v_cvt_pk_bf16_f32 v9, v198, v199
  v_cvt_pk_bf16_f32 v11, v242, v243
  v_cvt_pk_bf16_f32 v16, v200, v201
  v_cvt_pk_bf16_f32 v18, v244, v245
  v_cvt_pk_bf16_f32 v17, v202, v203
  v_cvt_pk_bf16_f32 v19, v246, v247
  s_add_u32 s48, s32, 40960
  s_add_u32 s49, s31, 40960
  buffer_store_dwordx4 v[8:11], v2, s[16:19], s48 offen sc1
  buffer_store_dwordx4 v[16:19], v234, s[16:19], s49 offen sc1
  v_mfma_f32_16x16x32_bf16 v[100:103], v[76:79], v[88:91], v[220:223]
  v_mfma_f32_16x16x32_bf16 v[116:119], v[92:95], v[104:107], v[220:223]
  v_mfma_f32_16x16x32_bf16 v[96:99], v[92:95], v[88:91], v[224:227]
  v_mfma_f32_16x16x32_bf16 v[112:115], v[108:111], v[104:107], v[224:227]
  s_nop 4
  v_max3_f32 v188, v100, v101, v102
  v_max3_f32 v190, v116, v117, v118
  v_max3_f32 v189, v103, v96, v97
  v_max3_f32 v191, v119, v112, v113
  v_max3_f32 v188, v188, v98, v99
  v_max3_f32 v190, v190, v114, v115
  v_max_f32 v188, v188, v189
  v_max_f32 v190, v190, v191
  v_mov_b32 v189, v188
  v_mov_b32 v191, v190
  s_nop 0
  v_permlane32_swap_b32 v188, v189
  v_permlane32_swap_b32 v190, v191
  v_max_f32 v188, v188, v189
  v_max_f32 v190, v190, v191
  v_mov_b32 v189, v188
  v_mov_b32 v191, v190
  s_nop 0
  v_permlane16_swap_b32 v188, v189
  v_permlane16_swap_b32 v190, v191
  v_max_f32 v188, v188, v189
  v_max_f32 v190, v190, v191
  v_mul_f32 v188, v233, v188
  v_mul_f32 v190, v233, v190
  v_pk_fma_f32 v[100:101], v[100:101], v[232:233], v[188:189] op_sel_hi:[1,0,0]
  v_pk_fma_f32 v[116:117], v[116:117], v[232:233], v[190:191] op_sel_hi:[1,0,0]
  v_pk_fma_f32 v[102:103], v[102:103], v[232:233], v[188:189] op_sel_hi:[1,0,0]
  v_pk_fma_f32 v[118:119], v[118:119], v[232:233], v[190:191] op_sel_hi:[1,0,0]
  v_pk_fma_f32 v[96:97], v[96:97], v[232:233], v[188:189] op_sel_hi:[1,0,0]
  v_pk_fma_f32 v[112:113], v[112:113], v[232:233], v[190:191] op_sel_hi:[1,0,0]
  v_pk_fma_f32 v[98:99], v[98:99], v[232:233], v[188:189] op_sel_hi:[1,0,0]
  v_pk_fma_f32 v[114:115], v[114:115], v[232:233], v[190:191] op_sel_hi:[1,0,0]
  v_exp_f32 v100, v100
  v_exp_f32 v116, v116
  v_exp_f32 v101, v101
  v_exp_f32 v117, v117
  v_exp_f32 v102, v102
  v_exp_f32 v118, v118
  v_exp_f32 v103, v103
  v_exp_f32 v119, v119
  v_exp_f32 v96, v96
  v_exp_f32 v112, v112
  v_exp_f32 v97, v97
  v_exp_f32 v113, v113
  v_exp_f32 v98, v98
  v_exp_f32 v114, v114
  v_exp_f32 v99, v99
  v_exp_f32 v115, v115
  v_cvt_pk_bf16_f32 v192, v100, v101
  v_cvt_pk_bf16_f32 v236, v116, v117
  v_cvt_pk_bf16_f32 v193, v102, v103
  v_cvt_pk_bf16_f32 v237, v118, v119
  v_cvt_pk_bf16_f32 v194, v96, v97
  v_cvt_pk_bf16_f32 v238, v112, v113
  v_cvt_pk_bf16_f32 v195, v98, v99
  v_cvt_pk_bf16_f32 v239, v114, v115
  s_nop 0
  v_mfma_f32_16x16x32_bf16 v[204:207], v[216:219], v[192:195], 0
  v_mfma_f32_16x16x32_bf16 v[248:251], v[216:219], v[236:239], 0
  v_mfma_f32_16x16x32_bf16 v[196:199], v[160:163], v[192:195], 0
  v_mfma_f32_16x16x32_bf16 v[240:243], v[162:165], v[236:239], 0
  v_mfma_f32_16x16x32_bf16 v[200:203], v[178:181], v[192:195], 0
  v_mfma_f32_16x16x32_bf16 v[244:247], v[180:183], v[236:239], 0
  s_nop 2
  v_rcp_f32 v204, v204
  v_rcp_f32 v248, v248
  v_pk_mul_f32 v[196:197], v[196:197], v[204:205] op_sel_hi:[1,0]
  v_pk_mul_f32 v[240:241], v[240:241], v[248:249] op_sel_hi:[1,0]
  v_pk_mul_f32 v[198:199], v[198:199], v[204:205] op_sel_hi:[1,0]
  v_pk_mul_f32 v[242:243], v[242:243], v[248:249] op_sel_hi:[1,0]
  v_pk_mul_f32 v[200:201], v[200:201], v[204:205] op_sel_hi:[1,0]
  v_pk_mul_f32 v[244:245], v[244:245], v[248:249] op_sel_hi:[1,0]
  v_pk_mul_f32 v[202:203], v[202:203], v[204:205] op_sel_hi:[1,0]
  v_pk_mul_f32 v[246:247], v[246:247], v[248:249] op_sel_hi:[1,0]
  v_cvt_pk_bf16_f32 v8, v196, v197
  v_cvt_pk_bf16_f32 v10, v240, v241
  v_cvt_pk_bf16_f32 v9, v198, v199
  v_cvt_pk_bf16_f32 v11, v242, v243
  v_cvt_pk_bf16_f32 v16, v200, v201
  v_cvt_pk_bf16_f32 v18, v244, v245
  v_cvt_pk_bf16_f32 v17, v202, v203
  v_cvt_pk_bf16_f32 v19, v246, v247
  s_add_u32 s48, s32, 81920
  s_add_u32 s49, s31, 81920
  buffer_store_dwordx4 v[8:11], v2, s[16:19], s48 offen sc1
  buffer_store_dwordx4 v[16:19], v234, s[16:19], s49 offen sc1
  v_mfma_f32_16x16x32_bf16 v[132:135], v[108:111], v[120:123], v[220:223]
  v_mfma_f32_16x16x32_bf16 v[148:151], v[124:127], v[136:139], v[220:223]
  v_mfma_f32_16x16x32_bf16 v[128:131], v[124:127], v[120:123], v[224:227]
  v_mfma_f32_16x16x32_bf16 v[144:147], v[140:143], v[136:139], v[224:227]
  s_nop 4
  v_max3_f32 v188, v132, v133, v134
  v_max3_f32 v190, v148, v149, v150
  v_max3_f32 v189, v135, v128, v129
  v_max3_f32 v191, v151, v144, v145
  v_max3_f32 v188, v188, v130, v131
  v_max3_f32 v190, v190, v146, v147
  v_max_f32 v188, v188, v189
  v_max_f32 v190, v190, v191
  v_mov_b32 v189, v188
  v_mov_b32 v191, v190
  s_nop 0
  v_permlane32_swap_b32 v188, v189
  v_permlane32_swap_b32 v190, v191
  v_max_f32 v188, v188, v189
  v_max_f32 v190, v190, v191
  v_mov_b32 v189, v188
  v_mov_b32 v191, v190
  s_nop 0
  v_permlane16_swap_b32 v188, v189
  v_permlane16_swap_b32 v190, v191
  v_max_f32 v188, v188, v189
  v_max_f32 v190, v190, v191
  v_mul_f32 v188, v233, v188
  v_mul_f32 v190, v233, v190
  v_pk_fma_f32 v[132:133], v[132:133], v[232:233], v[188:189] op_sel_hi:[1,0,0]
  v_pk_fma_f32 v[148:149], v[148:149], v[232:233], v[190:191] op_sel_hi:[1,0,0]
  v_pk_fma_f32 v[134:135], v[134:135], v[232:233], v[188:189] op_sel_hi:[1,0,0]
  v_pk_fma_f32 v[150:151], v[150:151], v[232:233], v[190:191] op_sel_hi:[1,0,0]
  v_pk_fma_f32 v[128:129], v[128:129], v[232:233], v[188:189] op_sel_hi:[1,0,0]
  v_pk_fma_f32 v[144:145], v[144:145], v[232:233], v[190:191] op_sel_hi:[1,0,0]
  v_pk_fma_f32 v[130:131], v[130:131], v[232:233], v[188:189] op_sel_hi:[1,0,0]
  v_pk_fma_f32 v[146:147], v[146:147], v[232:233], v[190:191] op_sel_hi:[1,0,0]
  v_exp_f32 v132, v132
  v_exp_f32 v148, v148
  v_exp_f32 v133, v133
  v_exp_f32 v149, v149
  v_exp_f32 v134, v134
  v_exp_f32 v150, v150
  v_exp_f32 v135, v135
  v_exp_f32 v151, v151
  v_exp_f32 v128, v128
  v_exp_f32 v144, v144
  v_exp_f32 v129, v129
  v_exp_f32 v145, v145
  v_exp_f32 v130, v130
  v_exp_f32 v146, v146
  v_exp_f32 v131, v131
  v_exp_f32 v147, v147
  v_cvt_pk_bf16_f32 v192, v132, v133
  v_cvt_pk_bf16_f32 v236, v148, v149
  v_cvt_pk_bf16_f32 v193, v134, v135
  v_cvt_pk_bf16_f32 v237, v150, v151
  v_cvt_pk_bf16_f32 v194, v128, v129
  v_cvt_pk_bf16_f32 v238, v144, v145
  v_cvt_pk_bf16_f32 v195, v130, v131
  v_cvt_pk_bf16_f32 v239, v146, v147
  s_nop 0
  v_mfma_f32_16x16x32_bf16 v[204:207], v[216:219], v[192:195], 0
  v_mfma_f32_16x16x32_bf16 v[248:251], v[216:219], v[236:239], 0
  v_mfma_f32_16x16x32_bf16 v[196:199], v[164:167], v[192:195], 0
  v_mfma_f32_16x16x32_bf16 v[240:243], v[166:169], v[236:239], 0
  v_mfma_f32_16x16x32_bf16 v[200:203], v[182:185], v[192:195], 0
  v_mfma_f32_16x16x32_bf16 v[244:247], v[184:187], v[236:239], 0
  s_nop 2
  v_rcp_f32 v204, v204
  v_rcp_f32 v248, v248
  v_pk_mul_f32 v[196:197], v[196:197], v[204:205] op_sel_hi:[1,0]
  v_pk_mul_f32 v[240:241], v[240:241], v[248:249] op_sel_hi:[1,0]
  v_pk_mul_f32 v[198:199], v[198:199], v[204:205] op_sel_hi:[1,0]
  v_pk_mul_f32 v[242:243], v[242:243], v[248:249] op_sel_hi:[1,0]
  v_pk_mul_f32 v[200:201], v[200:201], v[204:205] op_sel_hi:[1,0]
  v_pk_mul_f32 v[244:245], v[244:245], v[248:249] op_sel_hi:[1,0]
  v_pk_mul_f32 v[202:203], v[202:203], v[204:205] op_sel_hi:[1,0]
  v_pk_mul_f32 v[246:247], v[246:247], v[248:249] op_sel_hi:[1,0]
  v_cvt_pk_bf16_f32 v8, v196, v197
  v_cvt_pk_bf16_f32 v10, v240, v241
  v_cvt_pk_bf16_f32 v9, v198, v199
  v_cvt_pk_bf16_f32 v11, v242, v243
  v_cvt_pk_bf16_f32 v16, v200, v201
  v_cvt_pk_bf16_f32 v18, v244, v245
  v_cvt_pk_bf16_f32 v17, v202, v203
  v_cvt_pk_bf16_f32 v19, v246, v247
  s_add_u32 s48, s32, 122880
  s_add_u32 s49, s31, 122880
  buffer_store_dwordx4 v[8:11], v2, s[16:19], s48 offen sc1
  buffer_store_dwordx4 v[16:19], v234, s[16:19], s49 offen sc1
  s_lshl_b32 s30, s25, 7
  s_lshl_b32 s31, s26, 4
  s_add_u32 s30, s30, s31
  s_add_u32 s30, s30, 36864
  s_waitcnt vmcnt(0)
  s_mov_b64 exec, 1
  v_mov_b32 v2, 163780
  v_mov_b32 v3, 1
  ds_add_rtn_u32 v3, v2, v3
  s_waitcnt lgkmcnt(0)
  v_readfirstlane_b32 s31, v3
  s_cmp_lg_u32 s31, 3
  s_cbranch_scc1 P1_QSIG
  s_mov_b64 exec, 1
  v_mul_u32_u24 v2, 0, v1
  v_mov_b32 v3, s94
  buffer_store_dword v3, v2, s[16:19], s30 offen sc1
P1_QSIG:
  s_mov_b64 exec, -1
  s_branch P3_ENTRY
P3_ENTRY:
  s_and_b32 s25, s2, 7
  s_lshr_b32 s26, s2, 3
  s_lshr_b32 s27, s25, 1
  s_lshl_b32 s27, s27, 3
  s_and_b32 s28, s26, 7
  s_add_u32 s27, s27, s28
  s_and_b32 s28, s25, 1
  s_lshl_b32 s28, s28, 2
  s_lshr_b32 s29, s26, 3
  s_add_u32 s28, s28, s29
  s_cmp_lt_u32 s24, 4
  s_cbranch_scc1 P3_CONS
  s_mov_b32 s20, s84
  s_and_b32 s21, s85, 0xffff
  s_mov_b32 s22, 7077888
  s_mov_b32 s23, 0x20000
  v_lshlrev_b32 v2, 4, v1
  v_lshrrev_b32 v3, 3, v1
  v_bfe_u32 v4, v1, 4, 2
  v_lshlrev_b32 v4, 1, v4
  v_and_b32 v5, 7, v1
  v_xor_b32 v4, v4, v5
  v_lshlrev_b32 v4, 4, v4
  v_lshl_add_u32 v3, v3, 12, v4
  s_mul_i32 s30, s28, 102400
  s_add_u32 s30, s30, 5308416
  s_mul_i32 s31, s28, 276480
  s_add_u32 s31, s31, 6160384
  s_mul_i32 s32, s27, 81920
  s_add_u32 s32, s32, 8388608
  s_lshl_b32 s33, s27, 7
  s_cmp_lg_u32 s24, 4
  s_cbranch_scc1 P3_L0_NEXT
  v_min_u32 v7, 19, v1
  s_lshl_b32 s37, s28, 5
  v_add_u32 v7, s37, v7
  v_lshlrev_b32 v6, 4, v7
  v_add_u32 v6, 32768, v6
  s_mov_b32 s37, 0
P3_POLLW:
  buffer_load_dword v8, v6, s[16:19], 0 offen sc1
  s_waitcnt vmcnt(0)
  v_cmp_ne_u32 vcc, s94, v8
  s_add_u32 s37, s37, 1
  s_cmp_eq_u64 vcc, 0
  s_cbranch_scc1 P3_POLLW_OK
  s_cmp_lt_u32 s37, 0x8000
  s_cbranch_scc0 P3_POLLW_OK
  s_sleep 2
  s_branch P3_POLLW
P3_POLLW_OK:
  v_mov_b32 v6, 163792
  v_mov_b32 v7, 1
  ds_write_b32 v6, v7
  s_waitcnt lgkmcnt(0)
  s_mov_b32 s36, s90
  s_and_b32 s37, s91, 0xffff
  s_mov_b32 s38, 256
  s_mov_b32 s39, 0x20000
  s_mov_b64 exec, 1
  v_mov_b32 v6, 0
  v_mov_b32 v7, 1
  buffer_atomic_add v7, v6, s[36:39], 0 offen sc0
  s_waitcnt vmcnt(0)
  v_readfirstlane_b32 s37, v7
  s_cmp_lg_u32 s37, 255
  s_cbranch_scc1 P3_NOEPOCH
  v_mov_b32 v6, 49152
  v_mov_b32 v7, s94
  buffer_store_dword v7, v6, s[16:19], 0 offen sc1
P3_NOEPOCH:
  s_mov_b64 exec, -1
  v_mov_b32 v6, 163780
  s_mov_b32 s37, 0
P3_JOIN0:
  ds_read_b32 v7, v6
  s_waitcnt lgkmcnt(0)
  v_readfirstlane_b32 s38, v7
  s_add_u32 s37, s37, 1
  s_cmp_ge_u32 s38, s50
  s_cbranch_scc1 P3_JOIN0_OK
  s_cmp_lt_u32 s37, 0x400000
  s_cbranch_scc0 P3_JOIN0_OK
  s_sleep 1
  s_branch P3_JOIN0
P3_JOIN0_OK:
  s_mov_b32 s34, 0
  s_mov_b32 s36, 5
P3_L0_S_0:
  s_add_u32 m0, s34, 0
  s_nop 0
  buffer_load_dwordx4 v2, s[16:19], s30 offen sc1 lds
  s_add_u32 m0, s34, 1024
  s_add_u32 s35, s30, 1024
  buffer_load_dwordx4 v2, s[16:19], s35 offen sc1 lds
  s_add_u32 m0, s34, 2048
  s_add_u32 s35, s30, 2048
  buffer_load_dwordx4 v2, s[16:19], s35 offen sc1 lds
  s_add_u32 m0, s34, 3072
  s_add_u32 s35, s30, 3072
  buffer_load_dwordx4 v2, s[16:19], s35 offen sc1 lds
  s_add_u32 m0, s34, 4096
  s_add_u32 s35, s30, 4096
  buffer_load_dwordx4 v2, s[16:19], s35 offen sc1 lds
  s_add_u32 s30, s30, 10240
  s_add_u32 s34, s34, 20480
  s_cmp_eq_u32 s34, 102400
  s_cselect_b32 s34, 0, s34
  s_sub_u32 s36, s36, 1
  s_cmp_lg_u32 s36, 0
  s_cbranch_scc1 P3_L0_S_0
  s_waitcnt vmcnt(20)
  s_barrier
  s_mov_b32 s36, 5
P3_L0_S_2:
  s_waitcnt vmcnt(15)
  s_barrier
  s_add_u32 m0, s34, 0
  s_nop 0
  buffer_load_dwordx4 v2, s[16:19], s30 offen sc1 lds
  s_add_u32 m0, s34, 1024
  s_add_u32 s35, s30, 1024
  buffer_load_dwordx4 v2, s[16:19], s35 offen sc1 lds
  s_add_u32 m0, s34, 2048
  s_add_u32 s35, s30, 2048
  buffer_load_dwordx4 v2, s[16:19], s35 offen sc1 lds
  s_add_u32 m0, s34, 3072
  s_add_u32 s35, s30, 3072
  buffer_load_dwordx4 v2, s[16:19], s35 offen sc1 lds
  s_add_u32 m0, s34, 4096
  s_add_u32 s35, s30, 4096
  buffer_load_dwordx4 v2, s[16:19], s35 offen sc1 lds
  s_add_u32 s30, s30, 10240
  s_add_u32 s34, s34, 20480
  s_cmp_eq_u32 s34, 102400
  s_cselect_b32 s34, 0, s34
  s_sub_u32 s36, s36, 1
  s_cmp_lg_u32 s36, 0
  s_cbranch_scc1 P3_L0_S_2
  s_waitcnt vmcnt(15)
  s_barrier
  s_add_u32 m0, s34, 0
  s_nop 0
  buffer_load_dwordx4 v3, s[20:23], s33 offen  lds
  s_add_u32 m0, s34, 1024
  s_add_u32 s35, s33, 32768
  buffer_load_dwordx4 v3, s[20:23], s35 offen  lds
  s_add_u32 m0, s34, 2048
  s_add_u32 s35, s33, 65536
  buffer_load_dwordx4 v3, s[20:23], s35 offen  lds
  s_add_u32 m0, s34, 3072
  s_add_u32 s35, s33, 98304
  buffer_load_dwordx4 v3, s[20:23], s35 offen  lds
  s_add_u32 s33, s33, 262144
  s_add_u32 s34, s34, 20480
  s_cmp_eq_u32 s34, 102400
  s_cselect_b32 s34, 0, s34
  s_waitcnt vmcnt(14)
  s_barrier
  s_add_u32 m0, s34, 0
  s_nop 0
  buffer_load_dwordx4 v3, s[20:23], s33 offen  lds
  s_add_u32 m0, s34, 1024
  s_add_u32 s35, s33, 32768
  buffer_load_dwordx4 v3, s[20:23], s35 offen  lds
  s_add_u32 m0, s34, 2048
  s_add_u32 s35, s33, 65536
  buffer_load_dwordx4 v3, s[20:23], s35 offen  lds
  s_add_u32 m0, s34, 3072
  s_add_u32 s35, s33, 98304
  buffer_load_dwordx4 v3, s[20:23], s35 offen  lds
  s_add_u32 s33, s33, 262144
  s_add_u32 s34, s34, 20480
  s_cmp_eq_u32 s34, 102400
  s_cselect_b32 s34, 0, s34
  s_waitcnt vmcnt(13)
  s_barrier
  s_add_u32 m0, s34, 0
  s_nop 0
  buffer_load_dwordx4 v3, s[20:23], s33 offen  lds
  s_add_u32 m0, s34, 1024
  s_add_u32 s35, s33, 32768
  buffer_load_dwordx4 v3, s[20:23], s35 offen  lds
  s_add_u32 m0, s34, 2048
  s_add_u32 s35, s33, 65536
  buffer_load_dwordx4 v3, s[20:23], s35 offen  lds
  s_add_u32 m0, s34, 3072
  s_add_u32 s35, s33, 98304
  buffer_load_dwordx4 v3, s[20:23], s35 offen  lds
  s_add_u32 s33, s33, 262144
  s_add_u32 s34, s34, 20480
  s_cmp_eq_u32 s34, 102400
  s_cselect_b32 s34, 0, s34
  s_mov_b32 s36, 24
P3_L0_S_6:
  s_waitcnt vmcnt(12)
  s_barrier
  s_add_u32 m0, s34, 0
  s_nop 0
  buffer_load_dwordx4 v3, s[20:23], s33 offen  lds
  s_add_u32 m0, s34, 1024
  s_add_u32 s35, s33, 32768
  buffer_load_dwordx4 v3, s[20:23], s35 offen  lds
  s_add_u32 m0, s34, 2048
  s_add_u32 s35, s33, 65536
  buffer_load_dwordx4 v3, s[20:23], s35 offen  lds
  s_add_u32 m0, s34, 3072
  s_add_u32 s35, s33, 98304
  buffer_load_dwordx4 v3, s[20:23], s35 offen  lds
  s_add_u32 s33, s33, 262144
  s_add_u32 s34, s34, 20480
  s_cmp_eq_u32 s34, 102400
  s_cselect_b32 s34, 0, s34
  s_sub_u32 s36, s36, 1
  s_cmp_lg_u32 s36, 0
  s_cbranch_scc1 P3_L0_S_6
  s_waitcnt vmcnt(12)
  s_barrier
  s_waitcnt vmcnt(8)
  s_barrier
  s_waitcnt vmcnt(4)
  s_barrier
  s_waitcnt vmcnt(0)
  s_barrier
  s_endpgm
P3_L0_NEXT:
  s_cmp_lg_u32 s24, 5
  s_cbranch_scc1 P3_L1_NEXT
  v_mov_b32 v6, 163792
  s_mov_b32 s37, 0
P3_GOW:
  ds_read_b32 v7, v6
  s_waitcnt lgkmcnt(0)
  v_readfirstlane_b32 s38, v7
  s_add_u32 s37, s37, 1
  s_cmp_ge_u32 s38, 1
  s_cbranch_scc1 P3_GOW_OK
  s_cmp_lt_u32 s37, 0x400000
  s_cbranch_scc0 P3_GOW_OK
  s_sleep 1
  s_branch P3_GOW
P3_GOW_OK:
  v_mov_b32 v6, 163780
  s_mov_b32 s37, 0
P3_JOIN1:
  ds_read_b32 v7, v6
  s_waitcnt lgkmcnt(0)
  v_readfirstlane_b32 s38, v7
  s_add_u32 s37, s37, 1
  s_cmp_ge_u32 s38, s50
  s_cbranch_scc1 P3_JOIN1_OK
  s_cmp_lt_u32 s37, 0x400000
  s_cbranch_scc0 P3_JOIN1_OK
  s_sleep 1
  s_branch P3_JOIN1
P3_JOIN1_OK:
  s_mov_b32 s34, 0
  s_mov_b32 s36, 5
P3_L1_S_0:
  s_add_u32 m0, s34, 5120
  s_add_u32 s35, s30, 5120
  buffer_load_dwordx4 v2, s[16:19], s35 offen sc1 lds
  s_add_u32 m0, s34, 6144
  s_add_u32 s35, s30, 6144
  buffer_load_dwordx4 v2, s[16:19], s35 offen sc1 lds
  s_add_u32 m0, s34, 7168
  s_add_u32 s35, s30, 7168
  buffer_load_dwordx4 v2, s[16:19], s35 offen sc1 lds
  s_add_u32 m0, s34, 8192
  s_add_u32 s35, s30, 8192
  buffer_load_dwordx4 v2, s[16:19], s35 offen sc1 lds
  s_add_u32 m0, s34, 9216
  s_add_u32 s35, s30, 9216
  buffer_load_dwordx4 v2, s[16:19], s35 offen sc1 lds
  s_add_u32 s30, s30, 10240
  s_add_u32 s34, s34, 20480
  s_cmp_eq_u32 s34, 102400
  s_cselect_b32 s34, 0, s34
  s_sub_u32 s36, s36, 1
  s_cmp_lg_u32 s36, 0
  s_cbranch_scc1 P3_L1_S_0
  s_waitcnt vmcnt(20)
  s_barrier
  s_mov_b32 s36, 5
P3_L1_S_2:
  s_waitcnt vmcnt(15)
  s_barrier
  s_add_u32 m0, s34, 5120
  s_add_u32 s35, s30, 5120
  buffer_load_dwordx4 v2, s[16:19], s35 offen sc1 lds
  s_add_u32 m0, s34, 6144
  s_add_u32 s35, s30, 6144
  buffer_load_dwordx4 v2, s[16:19], s35 offen sc1 lds
  s_add_u32 m0, s34, 7168
  s_add_u32 s35, s30, 7168
  buffer_load_dwordx4 v2, s[16:19], s35 offen sc1 lds
  s_add_u32 m0, s34, 8192
  s_add_u32 s35, s30, 8192
  buffer_load_dwordx4 v2, s[16:19], s35 offen sc1 lds
  s_add_u32 m0, s34, 9216
  s_add_u32 s35, s30, 9216
  buffer_load_dwordx4 v2, s[16:19], s35 offen sc1 lds
  s_add_u32 s30, s30, 10240
  s_add_u32 s34, s34, 20480
  s_cmp_eq_u32 s34, 102400
  s_cselect_b32 s34, 0, s34
  s_sub_u32 s36, s36, 1
  s_cmp_lg_u32 s36, 0
  s_cbranch_scc1 P3_L1_S_2
  s_waitcnt vmcnt(15)
  s_barrier
  s_add_u32 m0, s34, 4096
  s_add_u32 s35, s33, 131072
  buffer_load_dwordx4 v3, s[20:23], s35 offen  lds
  s_add_u32 m0, s34, 5120
  s_add_u32 s35, s33, 163840
  buffer_load_dwordx4 v3, s[20:23], s35 offen  lds
  s_add_u32 m0, s34, 6144
  s_add_u32 s35, s33, 196608
  buffer_load_dwordx4 v3, s[20:23], s35 offen  lds
  s_add_u32 m0, s34, 7168
  s_add_u32 s35, s33, 229376
  buffer_load_dwordx4 v3, s[20:23], s35 offen  lds
  s_add_u32 s33, s33, 262144
  s_add_u32 s34, s34, 20480
  s_cmp_eq_u32 s34, 102400
  s_cselect_b32 s34, 0, s34
  s_waitcnt vmcnt(14)
  s_barrier
  s_add_u32 m0, s34, 4096
  s_add_u32 s35, s33, 131072
  buffer_load_dwordx4 v3, s[20:23], s35 offen  lds
  s_add_u32 m0, s34, 5120
  s_add_u32 s35, s33, 163840
  buffer_load_dwordx4 v3, s[20:23], s35 offen  lds
  s_add_u32 m0, s34, 6144
  s_add_u32 s35, s33, 196608
  buffer_load_dwordx4 v3, s[20:23], s35 offen  lds
  s_add_u32 m0, s34, 7168
  s_add_u32 s35, s33, 229376
  buffer_load_dwordx4 v3, s[20:23], s35 offen  lds
  s_add_u32 s33, s33, 262144
  s_add_u32 s34, s34, 20480
  s_cmp_eq_u32 s34, 102400
  s_cselect_b32 s34, 0, s34
  s_waitcnt vmcnt(13)
  s_barrier
  s_add_u32 m0, s34, 4096
  s_add_u32 s35, s33, 131072
  buffer_load_dwordx4 v3, s[20:23], s35 offen  lds
  s_add_u32 m0, s34, 5120
  s_add_u32 s35, s33, 163840
  buffer_load_dwordx4 v3, s[20:23], s35 offen  lds
  s_add_u32 m0, s34, 6144
  s_add_u32 s35, s33, 196608
  buffer_load_dwordx4 v3, s[20:23], s35 offen  lds
  s_add_u32 m0, s34, 7168
  s_add_u32 s35, s33, 229376
  buffer_load_dwordx4 v3, s[20:23], s35 offen  lds
  s_add_u32 s33, s33, 262144
  s_add_u32 s34, s34, 20480
  s_cmp_eq_u32 s34, 102400
  s_cselect_b32 s34, 0, s34
  s_mov_b32 s36, 24
P3_L1_S_6:
  s_waitcnt vmcnt(12)
  s_barrier
  s_add_u32 m0, s34, 4096
  s_add_u32 s35, s33, 131072
  buffer_load_dwordx4 v3, s[20:23], s35 offen  lds
  s_add_u32 m0, s34, 5120
  s_add_u32 s35, s33, 163840
  buffer_load_dwordx4 v3, s[20:23], s35 offen  lds
  s_add_u32 m0, s34, 6144
  s_add_u32 s35, s33, 196608
  buffer_load_dwordx4 v3, s[20:23], s35 offen  lds
  s_add_u32 m0, s34, 7168
  s_add_u32 s35, s33, 229376
  buffer_load_dwordx4 v3, s[20:23], s35 offen  lds
  s_add_u32 s33, s33, 262144
  s_add_u32 s34, s34, 20480
  s_cmp_eq_u32 s34, 102400
  s_cselect_b32 s34, 0, s34
  s_sub_u32 s36, s36, 1
  s_cmp_lg_u32 s36, 0
  s_cbranch_scc1 P3_L1_S_6
  s_waitcnt vmcnt(12)
  s_barrier
  s_waitcnt vmcnt(8)
  s_barrier
  s_waitcnt vmcnt(4)
  s_barrier
  s_waitcnt vmcnt(0)
  s_barrier
  s_endpgm
P3_L1_NEXT:
  s_cmp_lg_u32 s24, 6
  s_cbranch_scc1 P3_L2_NEXT
  s_lshr_b32 s37, s27, 1
  s_lshl_b32 s37, s37, 7
  s_add_u32 s37, s37, 36864
  v_and_b32 v6, 7, v1
  v_lshlrev_b32 v6, 4, v6
  v_add_u32 v6, s37, v6
  s_mov_b32 s37, 0
P3_POLLO:
  buffer_load_dword v8, v6, s[16:19], 0 offen sc1
  s_waitcnt vmcnt(0)
  v_cmp_ne_u32 vcc, s94, v8
  s_add_u32 s37, s37, 1
  s_cmp_eq_u64 vcc, 0
  s_cbranch_scc1 P3_POLLO_OK
  s_cmp_lt_u32 s37, 0x8000
  s_cbranch_scc0 P3_POLLO_OK
  s_sleep 2
  s_branch P3_POLLO
P3_POLLO_OK:
  v_mov_b32 v6, 163788
  v_mov_b32 v7, 1
  ds_write_b32 v6, v7
  s_waitcnt lgkmcnt(0)
  s_mov_b32 s34, 10240
  s_mov_b32 s36, 4
P3_L2_S_0:
  s_add_u32 m0, s34, 0
  s_nop 0
  buffer_load_dwordx4 v2, s[16:19], s32 offen sc1 lds
  s_add_u32 m0, s34, 1024
  s_add_u32 s35, s32, 1024
  buffer_load_dwordx4 v2, s[16:19], s35 offen sc1 lds
  s_add_u32 m0, s34, 2048
  s_add_u32 s35, s32, 40960
  buffer_load_dwordx4 v2, s[16:19], s35 offen sc1 lds
  s_add_u32 m0, s34, 3072
  s_add_u32 s35, s32, 41984
  buffer_load_dwordx4 v2, s[16:19], s35 offen sc1 lds
  s_add_u32 s32, s32, 4096
  s_add_u32 s34, s34, 20480
  s_cmp_eq_u32 s34, 112640
  s_cselect_b32 s34, 10240, s34
  s_sub_u32 s36, s36, 1
  s_cmp_lg_u32 s36, 0
  s_cbranch_scc1 P3_L2_S_0
  s_mov_b32 s36, 6
P3_L2_S_1:
  s_waitcnt vmcnt(12)
  s_barrier
  s_add_u32 m0, s34, 0
  s_nop 0
  buffer_load_dwordx4 v2, s[16:19], s32 offen sc1 lds
  s_add_u32 m0, s34, 1024
  s_add_u32 s35, s32, 1024
  buffer_load_dwordx4 v2, s[16:19], s35 offen sc1 lds
  s_add_u32 m0, s34, 2048
  s_add_u32 s35, s32, 40960
  buffer_load_dwordx4 v2, s[16:19], s35 offen sc1 lds
  s_add_u32 m0, s34, 3072
  s_add_u32 s35, s32, 41984
  buffer_load_dwordx4 v2, s[16:19], s35 offen sc1 lds
  s_add_u32 s32, s32, 4096
  s_add_u32 s34, s34, 20480
  s_cmp_eq_u32 s34, 112640
  s_cselect_b32 s34, 10240, s34
  s_sub_u32 s36, s36, 1
  s_cmp_lg_u32 s36, 0
  s_cbranch_scc1 P3_L2_S_1
  s_waitcnt vmcnt(12)
  s_barrier
  s_add_u32 m0, s34, 0
  s_nop 0
  buffer_load_dwordx4 v2, s[16:19], s31 offen sc1 lds
  s_add_u32 m0, s34, 1024
  s_add_u32 s35, s31, 1024
  buffer_load_dwordx4 v2, s[16:19], s35 offen sc1 lds
  s_add_u32 m0, s34, 2048
  s_add_u32 s35, s31, 2048
  buffer_load_dwordx4 v2, s[16:19], s35 offen sc1 lds
  s_add_u32 m0, s34, 3072
  s_add_u32 s35, s31, 3072
  buffer_load_dwordx4 v2, s[16:19], s35 offen sc1 lds
  s_add_u32 m0, s34, 4096
  s_add_u32 s35, s31, 4096
  buffer_load_dwordx4 v2, s[16:19], s35 offen sc1 lds
  s_add_u32 s31, s31, 10240
  s_add_u32 s34, s34, 20480
  s_cmp_eq_u32 s34, 112640
  s_cselect_b32 s34, 10240, s34
  s_waitcnt vmcnt(13)
  s_barrier
  s_add_u32 m0, s34, 0
  s_nop 0
  buffer_load_dwordx4 v2, s[16:19], s31 offen sc1 lds
  s_add_u32 m0, s34, 1024
  s_add_u32 s35, s31, 1024
  buffer_load_dwordx4 v2, s[16:19], s35 offen sc1 lds
  s_add_u32 m0, s34, 2048
  s_add_u32 s35, s31, 2048
  buffer_load_dwordx4 v2, s[16:19], s35 offen sc1 lds
  s_add_u32 m0, s34, 3072
  s_add_u32 s35, s31, 3072
  buffer_load_dwordx4 v2, s[16:19], s35 offen sc1 lds
  s_add_u32 m0, s34, 4096
  s_add_u32 s35, s31, 4096
  buffer_load_dwordx4 v2, s[16:19], s35 offen sc1 lds
  s_add_u32 s31, s31, 10240
  s_add_u32 s34, s34, 20480
  s_cmp_eq_u32 s34, 112640
  s_cselect_b32 s34, 10240, s34
  s_waitcnt vmcnt(14)
  s_barrier
  s_add_u32 m0, s34, 0
  s_nop 0
  buffer_load_dwordx4 v2, s[16:19], s31 offen sc1 lds
  s_add_u32 m0, s34, 1024
  s_add_u32 s35, s31, 1024
  buffer_load_dwordx4 v2, s[16:19], s35 offen sc1 lds
  s_add_u32 m0, s34, 2048
  s_add_u32 s35, s31, 2048
  buffer_load_dwordx4 v2, s[16:19], s35 offen sc1 lds
  s_add_u32 m0, s34, 3072
  s_add_u32 s35, s31, 3072
  buffer_load_dwordx4 v2, s[16:19], s35 offen sc1 lds
  s_add_u32 m0, s34, 4096
  s_add_u32 s35, s31, 4096
  buffer_load_dwordx4 v2, s[16:19], s35 offen sc1 lds
  s_add_u32 s31, s31, 10240
  s_add_u32 s34, s34, 20480
  s_cmp_eq_u32 s34, 112640
  s_cselect_b32 s34, 10240, s34
  s_mov_b32 s36, 24
P3_L2_S_5:
  s_waitcnt vmcnt(15)
  s_barrier
  s_add_u32 m0, s34, 0
  s_nop 0
  buffer_load_dwordx4 v2, s[16:19], s31 offen sc1 lds
  s_add_u32 m0, s34, 1024
  s_add_u32 s35, s31, 1024
  buffer_load_dwordx4 v2, s[16:19], s35 offen sc1 lds
  s_add_u32 m0, s34, 2048
  s_add_u32 s35, s31, 2048
  buffer_load_dwordx4 v2, s[16:19], s35 offen sc1 lds
  s_add_u32 m0, s34, 3072
  s_add_u32 s35, s31, 3072
  buffer_load_dwordx4 v2, s[16:19], s35 offen sc1 lds
  s_add_u32 m0, s34, 4096
  s_add_u32 s35, s31, 4096
  buffer_load_dwordx4 v2, s[16:19], s35 offen sc1 lds
  s_add_u32 s31, s31, 10240
  s_add_u32 s34, s34, 20480
  s_cmp_eq_u32 s34, 112640
  s_cselect_b32 s34, 10240, s34
  s_sub_u32 s36, s36, 1
  s_cmp_lg_u32 s36, 0
  s_cbranch_scc1 P3_L2_S_5
  s_waitcnt vmcnt(15)
  s_barrier
  s_waitcnt vmcnt(10)
  s_barrier
  s_waitcnt vmcnt(5)
  s_barrier
  s_waitcnt vmcnt(0)
  s_barrier
  s_endpgm
P3_L2_NEXT:
  v_mov_b32 v6, 163788
  s_mov_b32 s37, 0
P3_GO3:
  ds_read_b32 v7, v6
  s_waitcnt lgkmcnt(0)
  v_readfirstlane_b32 s38, v7
  s_add_u32 s37, s37, 1
  s_cmp_ge_u32 s38, 1
  s_cbranch_scc1 P3_GO3_OK
  s_cmp_lt_u32 s37, 0x400000
  s_cbranch_scc0 P3_GO3_OK
  s_sleep 1
  s_branch P3_GO3
P3_GO3_OK:
  s_mov_b32 s34, 10240
  s_mov_b32 s36, 4
P3_L3_S_0:
  s_add_u32 m0, s34, 4096
  s_add_u32 s35, s32, 2048
  buffer_load_dwordx4 v2, s[16:19], s35 offen sc1 lds
  s_add_u32 m0, s34, 5120
  s_add_u32 s35, s32, 3072
  buffer_load_dwordx4 v2, s[16:19], s35 offen sc1 lds
  s_add_u32 m0, s34, 6144
  s_add_u32 s35, s32, 43008
  buffer_load_dwordx4 v2, s[16:19], s35 offen sc1 lds
  s_add_u32 m0, s34, 7168
  s_add_u32 s35, s32, 44032
  buffer_load_dwordx4 v2, s[16:19], s35 offen sc1 lds
  s_add_u32 s32, s32, 4096
  s_add_u32 s34, s34, 20480
  s_cmp_eq_u32 s34, 112640
  s_cselect_b32 s34, 10240, s34
  s_sub_u32 s36, s36, 1
  s_cmp_lg_u32 s36, 0
  s_cbranch_scc1 P3_L3_S_0
  s_mov_b32 s36, 6
P3_L3_S_1:
  s_waitcnt vmcnt(12)
  s_barrier
  s_add_u32 m0, s34, 4096
  s_add_u32 s35, s32, 2048
  buffer_load_dwordx4 v2, s[16:19], s35 offen sc1 lds
  s_add_u32 m0, s34, 5120
  s_add_u32 s35, s32, 3072
  buffer_load_dwordx4 v2, s[16:19], s35 offen sc1 lds
  s_add_u32 m0, s34, 6144
  s_add_u32 s35, s32, 43008
  buffer_load_dwordx4 v2, s[16:19], s35 offen sc1 lds
  s_add_u32 m0, s34, 7168
  s_add_u32 s35, s32, 44032
  buffer_load_dwordx4 v2, s[16:19], s35 offen sc1 lds
  s_add_u32 s32, s32, 4096
  s_add_u32 s34, s34, 20480
  s_cmp_eq_u32 s34, 112640
  s_cselect_b32 s34, 10240, s34
  s_sub_u32 s36, s36, 1
  s_cmp_lg_u32 s36, 0
  s_cbranch_scc1 P3_L3_S_1
  s_waitcnt vmcnt(12)
  s_barrier
  s_add_u32 m0, s34, 5120
  s_add_u32 s35, s31, 5120
  buffer_load_dwordx4 v2, s[16:19], s35 offen sc1 lds
  s_add_u32 m0, s34, 6144
  s_add_u32 s35, s31, 6144
  buffer_load_dwordx4 v2, s[16:19], s35 offen sc1 lds
  s_add_u32 m0, s34, 7168
  s_add_u32 s35, s31, 7168
  buffer_load_dwordx4 v2, s[16:19], s35 offen sc1 lds
  s_add_u32 m0, s34, 8192
  s_add_u32 s35, s31, 8192
  buffer_load_dwordx4 v2, s[16:19], s35 offen sc1 lds
  s_add_u32 m0, s34, 9216
  s_add_u32 s35, s31, 9216
  buffer_load_dwordx4 v2, s[16:19], s35 offen sc1 lds
  s_add_u32 s31, s31, 10240
  s_add_u32 s34, s34, 20480
  s_cmp_eq_u32 s34, 112640
  s_cselect_b32 s34, 10240, s34
  s_waitcnt vmcnt(13)
  s_barrier
  s_add_u32 m0, s34, 5120
  s_add_u32 s35, s31, 5120
  buffer_load_dwordx4 v2, s[16:19], s35 offen sc1 lds
  s_add_u32 m0, s34, 6144
  s_add_u32 s35, s31, 6144
  buffer_load_dwordx4 v2, s[16:19], s35 offen sc1 lds
  s_add_u32 m0, s34, 7168
  s_add_u32 s35, s31, 7168
  buffer_load_dwordx4 v2, s[16:19], s35 offen sc1 lds
  s_add_u32 m0, s34, 8192
  s_add_u32 s35, s31, 8192
  buffer_load_dwordx4 v2, s[16:19], s35 offen sc1 lds
  s_add_u32 m0, s34, 9216
  s_add_u32 s35, s31, 9216
  buffer_load_dwordx4 v2, s[16:19], s35 offen sc1 lds
  s_add_u32 s31, s31, 10240
  s_add_u32 s34, s34, 20480
  s_cmp_eq_u32 s34, 112640
  s_cselect_b32 s34, 10240, s34
  s_waitcnt vmcnt(14)
  s_barrier
  s_add_u32 m0, s34, 5120
  s_add_u32 s35, s31, 5120
  buffer_load_dwordx4 v2, s[16:19], s35 offen sc1 lds
  s_add_u32 m0, s34, 6144
  s_add_u32 s35, s31, 6144
  buffer_load_dwordx4 v2, s[16:19], s35 offen sc1 lds
  s_add_u32 m0, s34, 7168
  s_add_u32 s35, s31, 7168
  buffer_load_dwordx4 v2, s[16:19], s35 offen sc1 lds
  s_add_u32 m0, s34, 8192
  s_add_u32 s35, s31, 8192
  buffer_load_dwordx4 v2, s[16:19], s35 offen sc1 lds
  s_add_u32 m0, s34, 9216
  s_add_u32 s35, s31, 9216
  buffer_load_dwordx4 v2, s[16:19], s35 offen sc1 lds
  s_add_u32 s31, s31, 10240
  s_add_u32 s34, s34, 20480
  s_cmp_eq_u32 s34, 112640
  s_cselect_b32 s34, 10240, s34
  s_mov_b32 s36, 24
P3_L3_S_5:
  s_waitcnt vmcnt(15)
  s_barrier
  s_add_u32 m0, s34, 5120
  s_add_u32 s35, s31, 5120
  buffer_load_dwordx4 v2, s[16:19], s35 offen sc1 lds
  s_add_u32 m0, s34, 6144
  s_add_u32 s35, s31, 6144
  buffer_load_dwordx4 v2, s[16:19], s35 offen sc1 lds
  s_add_u32 m0, s34, 7168
  s_add_u32 s35, s31, 7168
  buffer_load_dwordx4 v2, s[16:19], s35 offen sc1 lds
  s_add_u32 m0, s34, 8192
  s_add_u32 s35, s31, 8192
  buffer_load_dwordx4 v2, s[16:19], s35 offen sc1 lds
  s_add_u32 m0, s34, 9216
  s_add_u32 s35, s31, 9216
  buffer_load_dwordx4 v2, s[16:19], s35 offen sc1 lds
  s_add_u32 s31, s31, 10240
  s_add_u32 s34, s34, 20480
  s_cmp_eq_u32 s34, 112640
  s_cselect_b32 s34, 10240, s34
  s_sub_u32 s36, s36, 1
  s_cmp_lg_u32 s36, 0
  s_cbranch_scc1 P3_L3_S_5
  s_waitcnt vmcnt(15)
  s_barrier
  s_waitcnt vmcnt(10)
  s_barrier
  s_waitcnt vmcnt(5)
  s_barrier
  s_waitcnt vmcnt(0)
  s_barrier
  s_endpgm
P3_CONS:
  s_mov_b32 s20, s72
  s_and_b32 s21, s73, 0xffff
  s_mov_b32 s22, 2621440
  s_mov_b32 s23, 0x20000
  s_mov_b32 s36, s86
  s_and_b32 s37, s87, 0xffff
  s_mov_b32 s38, 4096
  s_mov_b32 s39, 0x20000
  s_mov_b32 s40, s88
  s_and_b32 s41, s89, 0xffff
  s_mov_b32 s42, 2621440
  s_mov_b32 s43, 0x20000
  v_and_b32 v5, 15, v1
  s_lshl_b32 s30, s27, 6
  s_lshl_b32 s31, s24, 4
  s_add_u32 s30, s30, s31
  v_add_u32 v5, s30, v5
  v_mul_u32_u24 v6, 1280, v5
  v_lshrrev_b32 v7, 4, v1
  v_lshl_add_u32 v6, v7, 3, v6
  s_mul_i32 s31, s28, 160
  v_add_u32 v6, s31, v6
  v_lshlrev_b32 v5, 1, v5
  buffer_load_dwordx2 v[76:77], v6, s[20:23], 0 offen offset:0
  buffer_load_dwordx2 v[78:79], v6, s[20:23], 0 offen offset:32
  buffer_load_dwordx2 v[80:81], v6, s[20:23], 0 offen offset:64
  buffer_load_dwordx2 v[82:83], v6, s[20:23], 0 offen offset:96
  buffer_load_dwordx2 v[84:85], v6, s[20:23], 0 offen offset:128
  buffer_load_ushort v86, v5, s[36:39], 0 offen
  v_lshlrev_b32 v2, 4, v1
  s_lshr_b32 s31, s24, 1
  s_lshl_b32 s31, s31, 11
  s_and_b32 s30, s24, 1
  s_lshl_b32 s30, s30, 3
  s_add_u32 s31, s31, s30
  v_add_u32 v3, s31, v2
  v_lshrrev_b32 v7, 2, v1
  v_bfe_u32 v5, v1, 3, 2
  v_xor_b32 v5, s24, v5
  v_lshlrev_b32 v5, 5, v5
  v_lshl_add_u32 v5, v7, 7, v5
  v_and_b32 v7, 3, v1
  v_lshl_add_u32 v4, v7, 3, v5
  v_mov_b32 v8, 0
  v_mov_b32 v9, 0
  v_mov_b32 v10, 0
  v_mov_b32 v11, 0
  v_mov_b32 v12, 0
  v_mov_b32 v13, 0
  v_mov_b32 v14, 0
  v_mov_b32 v15, 0
  v_mov_b32 v16, 0
  v_mov_b32 v17, 0
  v_mov_b32 v18, 0
  v_mov_b32 v19, 0
  v_mov_b32 v20, 0
  v_mov_b32 v21, 0
  v_mov_b32 v22, 0
  v_mov_b32 v23, 0
  v_mov_b32 v24, 0
  v_mov_b32 v25, 0
  v_mov_b32 v26, 0
  v_mov_b32 v27, 0
  v_mov_b32 v52, 0
  v_mov_b32 v53, 0
  v_mov_b32 v54, 0
  v_mov_b32 v55, 0
  v_mov_b32 v56, 0
  v_mov_b32 v57, 0
  v_mov_b32 v58, 0
  v_mov_b32 v59, 0
  v_mov_b32 v60, 0
  v_mov_b32 v61, 0
  v_mov_b32 v62, 0
  v_mov_b32 v63, 0
  v_mov_b32 v64, 0
  v_mov_b32 v65, 0
  v_mov_b32 v66, 0
  v_mov_b32 v67, 0
  v_mov_b32 v68, 0
  v_mov_b32 v69, 0
  v_mov_b32 v70, 0
  v_mov_b32 v71, 0
  v_mov_b32 v72, 0
  v_mov_b32 v73, 0
  v_mov_b32 v74, 0
  v_mov_b32 v75, 0
  s_mov_b32 s34, 0
  s_mov_b32 s33, 10240
  v_add_u32 v3, 10240, v3
  v_add_u32 v89, 10240, v2
  s_mov_b32 s35, 10
P3_CO:
  s_cmp_lg_u32 s35, 4
  s_cbranch_scc1 P3_CO_NOPOLL
  s_cmp_lg_u32 s24, 1
  s_cbranch_scc1 P3_CO_NOPOLL
  s_lshl_b32 s51, s28, 8
  s_add_u32 s51, s51, 40960
  v_and_b32 v5, 15, v1
  v_min_u32 v5, 13, v5
  v_lshlrev_b32 v5, 4, v5
  v_add_u32 v5, s51, v5
  s_mov_b32 s51, 0
P3_POLLU:
  buffer_load_dword v7, v5, s[16:19], 0 offen sc1
  s_waitcnt vmcnt(0)
  v_cmp_ne_u32 vcc, s94, v7
  s_add_u32 s51, s51, 1
  s_cmp_eq_u64 vcc, 0
  s_cbranch_scc1 P3_POLLU_OK
  s_cmp_lt_u32 s51, 0x8000
  s_cbranch_scc0 P3_POLLU_OK
  s_sleep 2
  s_branch P3_POLLU
P3_POLLU_OK:
P3_CO_NOPOLL:
  s_barrier
  v_add_u32 v87, s34, v2
  v_add_u32 v88, s34, v3
  ds_read_b64 v[48:49], v88 offset:0
  ds_read_b64 v[50:51], v88 offset:1024
  v_mfma_f32_16x16x32_bf16 v[8:11], v[52:55], v[72:75], v[8:11]
  ds_read_b128 v[28:31], v87 offset:0
  ds_read_b128 v[32:35], v87 offset:1024
  v_mfma_f32_16x16x32_bf16 v[12:15], v[56:59], v[72:75], v[12:15]
  ds_read_b128 v[36:39], v87 offset:2048
  v_mfma_f32_16x16x32_bf16 v[16:19], v[60:63], v[72:75], v[16:19]
  ds_read_b128 v[40:43], v87 offset:3072
  v_mfma_f32_16x16x32_bf16 v[20:23], v[64:67], v[72:75], v[20:23]
  ds_read_b128 v[44:47], v87 offset:4096
  v_mfma_f32_16x16x32_bf16 v[24:27], v[68:71], v[72:75], v[24:27]
  ds_read_b64 v[72:73], v88 offset:4096
  ds_read_b64 v[74:75], v88 offset:5120
  ds_read_b128 v[52:55], v87 offset:5120
  ds_read_b128 v[56:59], v87 offset:6144
  ds_read_b128 v[60:63], v87 offset:7168
  ds_read_b128 v[64:67], v87 offset:8192
  ds_read_b128 v[68:71], v87 offset:9216
  s_add_u32 s34, s34, 20480
  s_cmp_eq_u32 s34, 102400
  s_cselect_b32 s34, 0, s34
  s_waitcnt lgkmcnt(11)
  v_mfma_f32_16x16x32_bf16 v[8:11], v[28:31], v[48:51], v[8:11]
  s_waitcnt lgkmcnt(10)
  v_mfma_f32_16x16x32_bf16 v[12:15], v[32:35], v[48:51], v[12:15]
  s_waitcnt lgkmcnt(9)
  v_mfma_f32_16x16x32_bf16 v[16:19], v[36:39], v[48:51], v[16:19]
  s_waitcnt lgkmcnt(8)
  v_mfma_f32_16x16x32_bf16 v[20:23], v[40:43], v[48:51], v[20:23]
  s_waitcnt lgkmcnt(7)
  v_mfma_f32_16x16x32_bf16 v[24:27], v[44:47], v[48:51], v[24:27]
  s_waitcnt lgkmcnt(0)
  s_sub_u32 s35, s35, 1
  s_cmp_lg_u32 s35, 0
  s_cbranch_scc1 P3_CO
  s_mov_b32 s35, 27
P3_CY:
  s_barrier
  v_add_u32 v87, s34, v89
  v_add_u32 v88, s34, v4
  ds_read_b64_tr_b16 v[48:49], v88 offset:0
  ds_read_b64_tr_b16 v[50:51], v88 offset:2048
  v_mfma_f32_16x16x32_bf16 v[8:11], v[52:55], v[72:75], v[8:11]
  ds_read_b128 v[28:31], v87 offset:0
  ds_read_b128 v[32:35], v87 offset:1024
  v_mfma_f32_16x16x32_bf16 v[12:15], v[56:59], v[72:75], v[12:15]
  ds_read_b128 v[36:39], v87 offset:2048
  v_mfma_f32_16x16x32_bf16 v[16:19], v[60:63], v[72:75], v[16:19]
  ds_read_b128 v[40:43], v87 offset:3072
  v_mfma_f32_16x16x32_bf16 v[20:23], v[64:67], v[72:75], v[20:23]
  ds_read_b128 v[44:47], v87 offset:4096
  v_mfma_f32_16x16x32_bf16 v[24:27], v[68:71], v[72:75], v[24:27]
  ds_read_b64_tr_b16 v[72:73], v88 offset:4096
  ds_read_b64_tr_b16 v[74:75], v88 offset:6144
  ds_read_b128 v[52:55], v87 offset:5120
  ds_read_b128 v[56:59], v87 offset:6144
  ds_read_b128 v[60:63], v87 offset:7168
  ds_read_b128 v[64:67], v87 offset:8192
  ds_read_b128 v[68:71], v87 offset:9216
  s_add_u32 s34, s34, 20480
  s_cmp_eq_u32 s34, 102400
  s_cselect_b32 s34, 0, s34
  s_waitcnt lgkmcnt(11)
  v_mfma_f32_16x16x32_bf16 v[8:11], v[28:31], v[48:51], v[8:11]
  s_waitcnt lgkmcnt(10)
  v_mfma_f32_16x16x32_bf16 v[12:15], v[32:35], v[48:51], v[12:15]
  s_waitcnt lgkmcnt(9)
  v_mfma_f32_16x16x32_bf16 v[16:19], v[36:39], v[48:51], v[16:19]
  s_waitcnt lgkmcnt(8)
  v_mfma_f32_16x16x32_bf16 v[20:23], v[40:43], v[48:51], v[20:23]
  s_waitcnt lgkmcnt(7)
  v_mfma_f32_16x16x32_bf16 v[24:27], v[44:47], v[48:51], v[24:27]
  s_waitcnt lgkmcnt(0)
  s_sub_u32 s35, s35, 1
  s_cmp_lg_u32 s35, 0
  s_cbranch_scc1 P3_CY
  v_mfma_f32_16x16x32_bf16 v[8:11], v[52:55], v[72:75], v[8:11]
  v_mfma_f32_16x16x32_bf16 v[12:15], v[56:59], v[72:75], v[12:15]
  v_mfma_f32_16x16x32_bf16 v[16:19], v[60:63], v[72:75], v[16:19]
  v_mfma_f32_16x16x32_bf16 v[20:23], v[64:67], v[72:75], v[20:23]
  v_mfma_f32_16x16x32_bf16 v[24:27], v[68:71], v[72:75], v[24:27]
  s_waitcnt vmcnt(0)
  v_lshlrev_b32 v86, 16, v86
  v_lshlrev_b32 v28, 16, v76
  v_and_b32 v29, 0xffff0000, v76
  v_lshlrev_b32 v30, 16, v77
  v_and_b32 v31, 0xffff0000, v77
  v_add_f32 v28, v28, v86
  v_add_f32 v29, v29, v86
  v_add_f32 v30, v30, v86
  v_add_f32 v31, v31, v86
  v_lshlrev_b32 v32, 16, v78
  v_and_b32 v33, 0xffff0000, v78
  v_lshlrev_b32 v34, 16, v79
  v_and_b32 v35, 0xffff0000, v79
  v_add_f32 v32, v32, v86
  v_add_f32 v33, v33, v86
  v_add_f32 v34, v34, v86
  v_add_f32 v35, v35, v86
  v_lshlrev_b32 v36, 16, v80
  v_and_b32 v37, 0xffff0000, v80
  v_lshlrev_b32 v38, 16, v81
  v_and_b32 v39, 0xffff0000, v81
  v_add_f32 v36, v36, v86
  v_add_f32 v37, v37, v86
  v_add_f32 v38, v38, v86
  v_add_f32 v39, v39, v86
  v_lshlrev_b32 v40, 16, v82
  v_and_b32 v41, 0xffff0000, v82
  v_lshlrev_b32 v42, 16, v83
  v_and_b32 v43, 0xffff0000, v83
  v_add_f32 v40, v40, v86
  v_add_f32 v41, v41, v86
  v_add_f32 v42, v42, v86
  v_add_f32 v43, v43, v86
  v_lshlrev_b32 v44, 16, v84
  v_and_b32 v45, 0xffff0000, v84
  v_lshlrev_b32 v46, 16, v85
  v_and_b32 v47, 0xffff0000, v85
  v_add_f32 v44, v44, v86
  v_add_f32 v45, v45, v86
  v_add_f32 v46, v46, v86
  v_add_f32 v47, v47, v86
  v_add_f32 v28, v28, v8
  v_add_f32 v29, v29, v9
  v_add_f32 v30, v30, v10
  v_add_f32 v31, v31, v11
  v_cvt_pk_bf16_f32 v28, v28, v29
  v_cvt_pk_bf16_f32 v29, v30, v31
  buffer_store_dwordx2 v[28:29], v6, s[40:43], 0 offen offset:0 nt
  v_add_f32 v32, v32, v12
  v_add_f32 v33, v33, v13
  v_add_f32 v34, v34, v14
  v_add_f32 v35, v35, v15
  v_cvt_pk_bf16_f32 v32, v32, v33
  v_cvt_pk_bf16_f32 v33, v34, v35
  buffer_store_dwordx2 v[32:33], v6, s[40:43], 0 offen offset:32 nt
  v_add_f32 v36, v36, v16
  v_add_f32 v37, v37, v17
  v_add_f32 v38, v38, v18
  v_add_f32 v39, v39, v19
  v_cvt_pk_bf16_f32 v36, v36, v37
  v_cvt_pk_bf16_f32 v37, v38, v39
  buffer_store_dwordx2 v[36:37], v6, s[40:43], 0 offen offset:64 nt
  v_add_f32 v40, v40, v20
  v_add_f32 v41, v41, v21
  v_add_f32 v42, v42, v22
  v_add_f32 v43, v43, v23
  v_cvt_pk_bf16_f32 v40, v40, v41
  v_cvt_pk_bf16_f32 v41, v42, v43
  buffer_store_dwordx2 v[40:41], v6, s[40:43], 0 offen offset:96 nt
  v_add_f32 v44, v44, v24
  v_add_f32 v45, v45, v25
  v_add_f32 v46, v46, v26
  v_add_f32 v47, v47, v27
  v_cvt_pk_bf16_f32 v44, v44, v45
  v_cvt_pk_bf16_f32 v45, v46, v47
  buffer_store_dwordx2 v[44:45], v6, s[40:43], 0 offen offset:128 nt
  s_endpgm
K_END:
  s_endpgm
.section .rodata,"a"
.p2align 6
.amdhsa_kernel parallel_sum__sliding_local_dilated__mixer_token_mlp__prompt_kernel
  .amdhsa_next_free_vgpr 256
  .amdhsa_next_free_sgpr 96
  .amdhsa_accum_offset 256
  .amdhsa_group_segment_fixed_size 0
  .amdhsa_kernarg_size 88
  .amdhsa_user_sgpr_count 2
  .amdhsa_user_sgpr_kernarg_segment_ptr 1
  .amdhsa_system_sgpr_workgroup_id_x 1
  .amdhsa_float_denorm_mode_32 3
.end_amdhsa_kernel
```
